```python
import torch

def _softmax(x, axis=-1):
    return torch.softmax(x, dim=axis)
def _gelu(x):
    return torch.nn.functional.gelu(x, approximate="tanh")
def _silu(x):
    return torch.nn.functional.silu(x)
def _sigmoid(x):
    return torch.sigmoid(x)
def _layernorm(x, axis=-1, eps=1e-5):
    m = x.mean(dim=axis, keepdim=True)
    v = x.var(dim=axis, keepdim=True, unbiased=False)
    return (x - m) / torch.sqrt(v + eps)
def _scatter_add(tgt, idx, src, axis=0):
    return tgt.clone().index_add_(axis, idx, src)
def _segment_sum(src, seg, n):
    out = torch.zeros((n,) + src.shape[1:], dtype=src.dtype)
    return out.index_add_(0, seg, src)
def _pad(x, pw):
    flat = tuple(v for pair in reversed(pw) for v in pair)
    return torch.nn.functional.pad(x, flat)

kernel_name = 'recurrent_scan__ssm_conv_s5__dense_activation_mish__prompt'

def setup_inputs():

    _w = (lambda a: (lambda t: t.to(torch.bfloat16) if t.is_floating_point() else t)(torch.as_tensor(a)))
    def _A_setup():
        B, S, D = 1, 2048, 512
        P = D
        Lambda_re = -0.5 * (lambda _x: torch.exp(torch.as_tensor(_x)))((lambda *s: torch.randn(*s, dtype=torch.bfloat16) * 0.8)(P))
        Lambda_im = (lambda *s: torch.randn(*s, dtype=torch.bfloat16) * 0.8)(P) * 1.0
        B_re = (lambda *s: torch.randn(*s, dtype=torch.bfloat16) * 0.8)(P, D) * (D ** -0.5)
        B_im = (lambda *s: torch.randn(*s, dtype=torch.bfloat16) * 0.8)(P, D) * (D ** -0.5)
        C_re = (lambda *s: torch.randn(*s, dtype=torch.bfloat16) * 0.8)(D, P) * (P ** -0.5)
        C_im = (lambda *s: torch.randn(*s, dtype=torch.bfloat16) * 0.8)(D, P) * (P ** -0.5)
        log_dt = (lambda *s: torch.randn(*s, dtype=torch.bfloat16) * 0.8)(P) * 0.3 - 2.0
        Dskip = (lambda *s: torch.randn(*s, dtype=torch.bfloat16) * 0.4)(D)
        return {
            "x": _w((lambda *s: torch.randn(*s, dtype=torch.bfloat16) * 0.05)(B, S, D)),
            "Lambda_re": _w(Lambda_re),
            "Lambda_im": _w(Lambda_im),
            "B_re": _w(B_re),
            "B_im": _w(B_im),
            "C_re": _w(C_re),
            "C_im": _w(C_im),
            "log_dt": _w(log_dt),
            "Dskip": _w(Dskip),
        }
    _A_in = _A_setup()

    def _B_setup():
        B, S, D, F = 1, 2048, 512, 1792
        return {
            "x": _w((lambda *s: torch.randn(*s, dtype=torch.bfloat16) * 0.05)(B, S, D)),
            "w1": _w((lambda *s: torch.randn(*s, dtype=torch.bfloat16) * 0.8)(D, F) * (D ** -0.5)),
            "b1": _w((lambda *s: torch.randn(*s, dtype=torch.bfloat16) * 0.8)(F)),
            "w2": _w((lambda *s: torch.randn(*s, dtype=torch.bfloat16) * 0.1)(F, D) * (F ** -0.5)),
        }
    _B_in = _B_setup()

    return {
        "A_x": _A_in["x"],
        "A_Lambda_re": _A_in["Lambda_re"],
        "A_Lambda_im": _A_in["Lambda_im"],
        "A_B_re": _A_in["B_re"],
        "A_B_im": _A_in["B_im"],
        "A_C_re": _A_in["C_re"],
        "A_C_im": _A_in["C_im"],
        "A_log_dt": _A_in["log_dt"],
        "A_Dskip": _A_in["Dskip"],
        "B_x": _B_in["x"],
        "B_w1": _B_in["w1"],
        "B_b1": _B_in["b1"],
        "B_w2": _B_in["w2"],
    }

def reference(A_x, A_Lambda_re, A_Lambda_im, A_B_re, A_B_im, A_C_re, A_C_im, A_log_dt, A_Dskip, B_x, B_w1, B_b1, B_w2):
    def _A_ref(x, Lambda_re, Lambda_im, B_re, B_im, C_re, C_im, log_dt, Dskip):
        Bsz, L, H = x.shape
        Lam = Lambda_re + 1j * Lambda_im
        Bmat = B_re + 1j * B_im
        Cmat = C_re + 1j * C_im
        dt = torch.exp(log_dt)
        Lam_bar = torch.exp(dt * Lam)
        B_bar = ((Lam_bar - 1.0) / Lam)[:, None] * Bmat
        Bu = torch.einsum("bld,pd->blp", x + 0j, B_bar)
        h = torch.zeros_like(Bu[:, 0, :])
        hs = []
        for t in range(L):
            h = Lam_bar[None, :] * h + Bu[:, t, :]
            hs.append(h)
        hseq = torch.stack(hs, 1)
        y = 2.0 * torch.einsum("blp,dp->bld", hseq, Cmat).real + x * Dskip[None, None, :]
        return y

    def _B_ref(x, w1, b1, w2):
        h = torch.einsum("bsd,df->bsf", x, w1) + b1
        sp = torch.log1p(torch.exp(-torch.abs(h))) + torch.where(h > 0, h, torch.zeros_like(h))
        act = h * torch.tanh(sp)
        return torch.einsum("bsf,fd->bsd", act, w2)

    x = A_x
    xn = _layernorm(x, axis=-1)
    s = _A_ref(xn, A_Lambda_re, A_Lambda_im, A_B_re, A_B_im, A_C_re, A_C_im, A_log_dt, A_Dskip)
    g = _silu(_B_ref(xn, B_w1, B_b1, B_w2))
    return x + s * g
```

```asm
; @launch grid=(256,1,1) block=(256,1,1) lds=163840
.amdgcn_target "amdgcn-amd-amdhsa--gfx950"
.text
.p2align 12
.globl recurrent_scan__ssm_conv_s5__dense_activation_mish__prompt_kernel
.p2align 8
.type recurrent_scan__ssm_conv_s5__dense_activation_mish__prompt_kernel,@function
recurrent_scan__ssm_conv_s5__dense_activation_mish__prompt_kernel:
    s_cmp_ge_u32 s2, 256
    s_cbranch_scc1 L_end
    s_load_dwordx16 s[4:19], s[0:1], 0
    s_load_dwordx16 s[20:35], s[0:1], 64
    s_getpc_b64 s[80:81]
    s_and_b32 s101, s2, 0xf8
    s_lshl_b32 s101, s101, 7
    v_lshl_add_u32 v100, v0, 2, s101
    global_load_dword v255, v100, s[80:81]
    v_readfirstlane_b32 s72, v0
    v_bfe_u32 v99, v0, 4, 2
    v_and_b32 v100, 7, v0
    v_xor_b32 v99, v99, v100
    v_bfe_u32 v101, v0, 3, 2
    v_bfe_u32 v97, v0, 5, 1
    v_lshl_add_u32 v101, v97, 4, v101
    v_lshlrev_b32 v99, 4, v99
    v_lshl_add_u32 v112, v101, 10, v99
    s_lshr_b32 s72, s72, 6
    s_and_b32 s75, s2, 6
    s_lshr_b32 s87, s2, 6
    s_lshl1_add_u32 s75, s75, s87
    s_lshl2_add_u32 s77, s75, s72
    s_bfe_u32 s97, s2, 0x10005
    s_bfe_u32 s94, s2, 0x20003
    s_xor_b32 s94, s94, 2
    s_lshl_b32 s99, s77, 8
    s_add_u32 s99, s99, s97
    s_lshl_b32 s99, s99, 7
    s_lshl_b32 s79, s94, 8
    s_lshl_b32 s73, s72, 12
    v_xor_b32_e64 v113, 64, v112
    v_add_u32 v114, 6144, v112
    v_add_u32 v115, 9216, v113
    v_add_u32 v113, 3072, v113
    s_mov_b32 s38, 2097152
    s_mov_b32 s39, 0x20000
    s_waitcnt lgkmcnt(0)
    s_mov_b64 s[36:37], s[4:5]
    s_add_u32 m0, s73, 147456
    s_add_u32 s87, s99, s79
    buffer_load_dwordx4 v112, s[36:39], s87 offen offset:0  lds
    buffer_load_dwordx4 v113, s[36:39], s87 offen offset:1024  lds
    buffer_load_dwordx4 v114, s[36:39], s87 offen offset:2048  lds
    buffer_load_dwordx4 v115, s[36:39], s87 offen offset:3072  lds
    v_and_b32 v96, 63, v0
    v_and_b32 v98, 31, v0
    v_lshlrev_b32 v211, 4, v96
    v_xor_b32 v100, 64, v99
    s_and_b32 s93, s2, 1
    s_lshl1_add_u32 s93, s93, s97
    s_lshl2_add_u32 s76, s93, s94
    s_xor_b32 s100, s99, 128
    s_and_b32 s91, s72, 1
    s_and_b32 s78, s75, 7
    s_lshl_b32 s78, s78, 2
    s_lshr_b32 s78, 1985229328, s78
    s_and_b32 s78, s78, 15
    s_mov_b32 s83, s94
    s_lshl_b32 s88, s76, 6
    v_lshl_add_u32 v104, v98, 1, s88
    s_mul_i32 s88, s93, 7
    s_add_u32 s88, s88, s94
    s_lshl_b32 s89, s88, 7
    s_cmp_eq_u32 s94, 3
    s_cselect_b32 s101, 0, 512
    s_add_u32 s90, s89, s101
    v_lshl_add_u32 v105, v98, 1, s89
    v_lshl_add_u32 v106, v98, 1, s90
    s_lshl1_add_u32 s92, s94, s97
    s_lshl1_add_u32 s98, s92, s91
    s_lshl_b32 s98, s98, 6
    v_lshl_add_u32 v107, v98, 1, s98
    v_mov_b32 v101, 262016
    s_mul_i32 s62, s75, 1049856
    s_add_u32 s62, s62, 2097152
    s_add_u32 s60, s34, s62
    s_addc_u32 s61, s35, 0
    s_mov_b32 s62, 0x100000
    s_mov_b32 s63, 0x20000
    global_load_ushort v220, v104, s[18:19]
    global_load_ushort v218, v104, s[6:7]
    global_load_ushort v219, v104, s[8:9]
    global_load_dword v252, v101, s[34:35] sc1
    global_load_ushort v254, v107, s[20:21]
    global_load_ushort v116, v105, s[26:27]
    global_load_ushort v118, v105, s[26:27] offset:64
    global_load_ushort v120, v106, s[26:27]
    global_load_ushort v122, v106, s[26:27] offset:64
    s_lshl4_add_u32 s88, s76, 15
    s_sub_u32 s88, s88, s75
    s_lshl2_add_u32 s88, s88, s72
    s_lshl_b32 s88, s88, 7
    s_add_u32 s88, s88, 262144
    v_mov_b32 v108, s88
    s_lshl2_add_u32 s88, s94, s72
    s_min_u32 s88, s88, 9
    s_lshl2_add_u32 s88, s88, s93
    s_lshl_b32 s88, s88, 7
    s_add_u32 s88, s88, 917504
    s_mov_b64 exec, 1
    global_load_dword v108, v108, s[34:35]
    buffer_load_dword v109, off, s[60:63], s88
    s_mov_b64 exec, -1
    s_mov_b64 s[44:45], s[24:25]
    s_mov_b32 s46, 1835008
    s_mov_b32 s47, 0x20000
    s_mov_b64 s[48:49], s[28:29]
    s_mov_b32 s50, 1835008
    s_mov_b32 s51, 0x20000
    s_cmp_lt_u32 s72, 2
    s_cselect_b64 s[40:41], s[10:11], s[12:13]
    s_mov_b32 s42, 524288
    s_mov_b32 s43, 0x20000
    s_cmp_lg_u32 s78, 0
    s_cbranch_scc1 L_tk0
    s_and_b32 s101, s76, 3
    s_lshl_b32 s101, s101, 2
    s_add_u32 s101, s101, s72
    s_mul_i32 s101, s101, 28672
    s_and_b32 s88, s78, 1
    s_mul_i32 s88, s88, 458752
    s_add_u32 s101, s101, s88
    s_bfe_u32 s88, s75, 65539
    s_mul_i32 s88, s88, 917504
    s_add_u32 s101, s101, s88
    s_lshr_b32 s88, s76, 2
    s_mul_i32 s88, s88, 896
    s_add_u32 s101, s101, s88
    v_lshrrev_b32 v236, 6, v211
    v_mul_u32_u24 v236, 3584, v236
    v_bfe_u32 v237, v211, 4, 2
    v_lshl_add_u32 v236, v237, 7, v236
    s_mov_b32 exec_hi, 0
    buffer_load_dword v238, v236, s[44:47], s101 offen
    s_mov_b64 exec, -1
L_tk0:
    s_add_u32 s101, s83, 1
    s_and_b32 s101, s101, 3
    s_lshl_b32 s80, s101, 8
    s_mul_i32 s84, s101, 458752
    s_add_u32 s101, s83, 2
    s_and_b32 s101, s101, 3
    s_lshl_b32 s81, s101, 8
    s_mul_i32 s85, s101, 458752
    s_add_u32 s101, s83, 3
    s_and_b32 s101, s101, 3
    s_lshl_b32 s82, s101, 8
    s_mul_i32 s86, s101, 458752
    s_mul_i32 s83, s83, 458752
    s_mov_b64 s[52:53], s[14:15]
    s_mov_b32 s54, 524288
    s_mov_b32 s55, 0x20000
    s_mov_b64 s[56:57], s[16:17]
    s_mov_b32 s58, 524288
    s_mov_b32 s59, 0x20000
    s_mov_b64 s[68:69], s[30:31]
    s_mov_b32 s70, 4194304
    s_mov_b32 s71, 0x20000
    s_cmp_lt_u32 s72, 2
    s_cselect_b64 s[8:9], 0, -1
    s_cmp_eq_u32 s91, 0
    s_cselect_b64 s[6:7], 0, -1
    s_mov_b32 s4, 0
    s_mov_b32 s5, -1
    s_lshl_b32 s101, s76, 13
    s_add_u32 s101, s101, 262144
    s_add_u32 s64, s34, s101
    s_addc_u32 s65, s35, 0
    s_mov_b32 s66, 8192
    s_mov_b32 s67, 0x20000
    s_lshl_b32 s101, s97, 1
    s_xor_b32 s101, s101, s72
    s_mul_i32 s101, s101, 114688
    s_add_u32 s89, s89, s101
    s_add_u32 s90, s90, s101
    s_mul_i32 s97, s72, 180224
    s_mul_i32 s101, s93, 28672
    s_add_u32 s95, s97, s101
    s_lshl_b32 s101, s94, 12
    s_add_u32 s95, s95, s101
    s_add_u32 s96, s95, 16384
    s_lshl_b32 s101, s76, 12
    s_add_u32 s97, s97, s101
    s_add_u32 s97, s97, 114688
    s_cmp_eq_u32 s94, 3
    s_cselect_b32 s90, 1073741824, s90
    s_cselect_b32 s96, 1073741824, s96
    s_and_b32 s18, s93, 2
    s_lshr_b32 s88, s72, 1
    s_add_u32 s20, s18, s88
    s_lshl2_add_u32 s88, s75, s20
    s_lshl_b32 s14, s88, 15
    s_add_u32 s14, s14, s98
    s_lshl_b32 s15, s14, 1
    s_mul_i32 s10, s20, 180224
    s_xor_b32 s88, s20, 1
    s_mul_i32 s11, s88, 180224
    s_lshl2_add_u32 s101, s73, 114688
    s_add_u32 s10, s10, s101
    s_add_u32 s11, s11, s101
    s_lshl_b32 s20, s20, 12
    s_add_u32 s20, s20, 65536
    s_xor_b32 s88, s76, 8
    s_add_u32 s93, s18, s91
    s_lshl1_add_u32 s18, s18, s72
    s_lshl_b32 s18, s18, 7
    s_add_u32 s18, s18, 920576
    s_lshl2_add_u32 s101, s76, s72
    s_lshl_b32 s101, s101, 11
    s_add_u32 s13, s101, 786432
    s_xor_b32 s12, s13, 0x10000
    s_sub_u32 s21, 16, s75
    s_lshl_b32 s21, s21, 9
    s_sub_u32 s16, s21, 512
    s_lshl_b32 s101, s72, 11
    s_add_u32 s21, s21, s101
    s_cmp_eq_u32 s72, 0
    s_cselect_b32 s16, s16, 1073741824
    s_lshl_b32 s101, s76, 8
    s_add_u32 s17, s101, s77
    s_and_b32 s88, s72, 2
    s_lshr_b32 s101, s76, 2
    s_lshl1_add_u32 s101, s88, s101
    s_lshl1_add_u32 s101, s101, s91
    s_lshl2_add_u32 s101, s101, s94
    s_lshl4_add_u32 s98, s101, 917504
    s_xor_b32 s19, s98, 256
    s_add_u32 s19, s19, 4096
    s_mul_i32 s3, s88, 180224
    s_mul_i32 s101, s93, 28672
    s_add_u32 s3, s3, s101
    s_lshl1_add_u32 s88, s88, s93
    s_lshl_b32 s88, s88, 7
    s_add_u32 s77, s88, 917504
    s_lshl_b32 s101, s92, 16
    s_lshl_b32 s92, s92, 7
    s_mul_i32 s88, s93, 458752
    s_add_u32 s92, s92, s88
    s_lshr_b32 s88, s72, 1
    s_lshl_b32 s88, s88, 15
    s_add_u32 s92, s92, s88
    s_lshl_b32 s88, s72, 8
    s_add_u32 s101, s101, s88
    s_lshl_b32 s88, s91, 15
    s_add_u32 s93, s101, s88
    s_xor_b32 s94, s93, 0x8000
    s_lshl_b32 s101, s91, 12
    s_add_u32 s101, s101, 81920
    s_lshl_b32 s91, s91, 7
    s_and_b32 s88, s99, 128
    s_xor_b32 s91, s91, s88
    s_lshl_b32 s88, s76, 15
    s_add_u32 s91, s91, s88
    v_bfe_u32 v101, v96, 2, 2
    v_lshlrev_b32 v208, 6, v101
    v_lshl_add_u32 v101, v97, 2, v101
    v_bfe_u32 v102, v96, 4, 1
    v_lshl_add_u32 v208, v102, 5, v208
    v_lshlrev_b32 v102, 6, v102
    v_and_b32 v253, 3, v96
    v_lshl_add_u32 v208, v253, 3, v208
    v_lshl_add_u32 v102, v253, 4, v102
    v_lshl_add_u32 v210, v97, 9, v208
    v_add_u32_e64 v210, s101, v210
    v_lshl_add_u32 v208, v97, 10, v208
    v_add_u32 v209, 0x10000, v208
    v_and_b32 v253, 0x70, v211
    v_mul_u32_u24 v196, 3584, v101
    v_add_u32_e64 v196, v196, v102
    v_add_u32 v197, 27648, v196
    v_add_u32 v198, 55296, v196
    v_add_u32 v199, 82944, v196
    v_lshl_add_u32 v200, v101, 10, v102
    v_add_u32 v201, 7168, v200
    v_add_u32 v202, 14336, v200
    v_add_u32 v203, 21504, v200
    v_lshrrev_b32_e64 v101, 3, v96
    v_lshl_add_u32 v192, v101, 10, v99
    v_lshl_add_u32 v193, v101, 10, v100
    v_add_u32 v194, 14336, v192
    v_add_u32 v195, 21504, v193
    v_add_u32 v193, 7168, v193
    v_bfe_u32 v101, v98, 1, 3
    v_xor_b32 v101, v101, v97
    v_lshlrev_b32 v101, 4, v101
    v_lshl_add_u32 v101, v98, 7, v101
    s_add_u32 s101, s73, 98304
    v_add_u32 v204, s101, v101
    v_xor_b32 v205, 32, v204
    v_xor_b32 v206, 64, v204
    v_xor_b32 v207, 0x60, v204
    s_lshl_b32 s101, s72, 1
    v_add_u32 v222, s101, v97
    v_cvt_f32_u32 v222, v222
    v_mul_f32 v222, 1098907648, v222
    v_mov_b32 v117, 0
    v_mov_b32 v119, 0
    v_mov_b32 v121, 0
    v_mov_b32 v123, 0
    v_mov_b32 v125, 0
    v_mov_b32 v126, 0
    v_mov_b32 v127, 0
    v_mov_b32 v124, 3140239289
    v_cndmask_b32 v124, v124, v125, s[4:5]
    v_mov_b32 v228, 0
    v_mov_b32 v230, 0
    v_mov_b32 v232, 0x3f803f80
    v_lshlrev_b32 v249, 4, v98
    v_add_u32 v249, 65536, v249
    v_lshl_add_u32 v248, v97, 3, v249
    v_add_u32 v248, s73, v248
    v_bfe_u32 v101, v96, 1, 2
    v_lshlrev_b32 v102, 1, v97
    v_xor_b32 v101, v101, v102
    v_lshlrev_b32 v101, 4, v101
    v_lshl_add_u32 v250, v98, 6, v101
    v_and_b32 v251, 0x2c0, v211
    v_and_b32 v99, 1, v96
    v_lshl_add_u32 v251, v99, 5, v251
    v_bfe_u32 v100, v96, 4, 1
    v_bfe_u32 v101, v96, 3, 1
    v_xor_b32 v104, v100, v101
    v_lshl_add_u32 v251, v104, 4, v251
    v_bfe_u32 v104, v96, 1, 1
    v_lshl_add_u32 v251, v104, 3, v251
    s_add_u32 s101, s73, 147456
    v_add_u32 v250, s101, v250
    v_add_u32 v251, s101, v251
    v_lshl_add_u32 v100, v100, 1, v104
    v_add_u32 v102, v102, v101
    v_xor_b32 v100, v100, v102
    v_lshlrev_b32_e64 v99, 3, v99
    v_lshl_add_u32 v99, v100, 4, v99
    v_bfe_u32 v100, v96, 2, 2
    v_lshl_add_u32 v100, v97, 2, v100
    v_lshl_add_u32 v99, v100, 7, v99
    s_and_b32 s101, s72, 1
    s_lshl_b32 s101, s101, 6
    s_add_u32 s101, s101, s20
    s_add_u32 s101, s101, 81920
    v_add_u32 v239, s101, v99
    s_waitcnt lgkmcnt(0)
    s_add_u32 m0, s73, 81920
    s_add_u32 s87, s100, s79
    buffer_load_dwordx4 v112, s[36:39], s87 offen offset:0  lds
    buffer_load_dwordx4 v113, s[36:39], s87 offen offset:1024  lds
    buffer_load_dwordx4 v114, s[36:39], s87 offen offset:2048  lds
    buffer_load_dwordx4 v115, s[36:39], s87 offen offset:3072  lds
    s_cmp_lg_u32 s78, 1
    s_cbranch_scc1 L_tk1
    s_and_b32 s101, s76, 3
    s_lshl_b32 s101, s101, 2
    s_add_u32 s101, s101, s72
    s_mul_i32 s101, s101, 28672
    s_and_b32 s88, s78, 1
    s_mul_i32 s88, s88, 458752
    s_add_u32 s101, s101, s88
    s_bfe_u32 s88, s75, 65539
    s_mul_i32 s88, s88, 917504
    s_add_u32 s101, s101, s88
    s_lshr_b32 s88, s76, 2
    s_mul_i32 s88, s88, 896
    s_add_u32 s101, s101, s88
    v_lshrrev_b32 v236, 6, v211
    v_mul_u32_u24 v236, 3584, v236
    v_bfe_u32 v237, v211, 4, 2
    v_lshl_add_u32 v236, v237, 7, v236
    s_mov_b32 exec_hi, 0
    buffer_load_dword v238, v236, s[44:47], s101 offen
    s_mov_b64 exec, -1
L_tk1:
    s_branch L_pad
.p2align 12
.fill 0, 4, 0xbf800000
L_pad:
    s_waitcnt vmcnt(15)
    ds_read_b128 v[0:3], v204 offset:49152
    ds_read_b128 v[4:7], v205 offset:49152
    ds_read_b128 v[8:11], v206 offset:49152
    ds_read_b128 v[12:15], v207 offset:49152
    s_add_u32 m0, s73, 98304
    s_add_u32 s87, s99, s80
    buffer_load_dwordx4 v112, s[36:39], s87 offen offset:0  lds
    buffer_load_dwordx4 v113, s[36:39], s87 offen offset:1024  lds
    buffer_load_dwordx4 v114, s[36:39], s87 offen offset:2048  lds
    buffer_load_dwordx4 v115, s[36:39], s87 offen offset:3072  lds
    s_cmp_lg_u32 s78, 2
    s_cbranch_scc1 L_tk2
    s_and_b32 s101, s76, 3
    s_lshl_b32 s101, s101, 2
    s_add_u32 s101, s101, s72
    s_lshl_b32 s101, s101, 12
    s_and_b32 s88, s78, 1
    s_mul_i32 s88, s88, 65536
    s_add_u32 s101, s101, s88
    s_bfe_u32 s88, s75, 65539
    s_mul_i32 s88, s88, 131072
    s_add_u32 s101, s101, s88
    s_lshr_b32 s88, s76, 2
    s_mul_i32 s88, s88, 458752
    s_add_u32 s101, s101, s88
    v_lshlrev_b32 v236, 3, v211
    s_mov_b32 exec_hi, 0
    buffer_load_dword v238, v236, s[48:51], s101 offen
    s_mov_b64 exec, -1
L_tk2:
    s_waitcnt vmcnt(13)
    v_lshl_or_b32 v116, v116, 16, v116
    s_waitcnt vmcnt(12)
    v_lshl_or_b32 v118, v118, 16, v118
    s_waitcnt vmcnt(11)
    v_lshl_or_b32 v120, v120, 16, v120
    s_waitcnt vmcnt(10)
    v_lshl_or_b32 v122, v122, 16, v122
    v_lshlrev_b32 v240, 16, v220
    v_mul_f32 v240, 1069066811, v240
    v_exp_f32 v240, v240
    v_lshlrev_b32 v246, 16, v218
    v_cvt_pk_bf16_f32 v240, v240, v240
    v_lshlrev_b32 v247, 16, v219
    v_and_b32 v240, 0xffff0000, v240
    v_mul_f32 v244, v240, v246
    v_mul_f32 v245, v240, v247
    v_mul_f32 v244, 1069066811, v244
    v_mul_f32 v245, 1042479491, v245
    v_mul_f32 v220, 1098907648, v222
    v_mul_f32 v240, 1065353216, v244
    v_mul_f32 v241, 1065353216, v245
    v_exp_f32 v240, v240
    v_fract_f32 v241, v241
    v_cos_f32 v242, v241
    v_sin_f32 v243, v241
    v_mul_f32 v212, v240, v242
    v_mul_f32 v213, v240, v243
    v_mul_f32 v240, 1073741824, v244
    v_mul_f32 v241, 1073741824, v245
    v_exp_f32 v240, v240
    v_fract_f32 v241, v241
    v_cos_f32 v242, v241
    v_sin_f32 v243, v241
    v_mul_f32 v224, v240, v242
    v_mul_f32 v225, v240, v243
    v_mul_f32 v240, 1098907648, v244
    v_mul_f32 v241, 1098907648, v245
    v_exp_f32 v240, v240
    v_fract_f32 v241, v241
    v_cos_f32 v242, v241
    v_sin_f32 v243, v241
    v_mul_f32 v216, v240, v242
    v_add_u32 v204, 4294934528, v204
    v_add_u32 v205, 4294934528, v205
    v_add_u32 v206, 4294934528, v206
    v_add_u32 v207, 4294934528, v207
    s_waitcnt vmcnt(4)
    ds_read_b128 v[16:19], v204 offset:16384
    ds_read_b128 v[20:23], v205 offset:16384
    ds_read_b128 v[24:27], v206 offset:16384
    ds_read_b128 v[28:31], v207 offset:16384
    s_add_u32 m0, s73, 65536
    s_add_u32 s87, s100, s80
    buffer_load_dwordx4 v112, s[36:39], s87 offen offset:0  lds
    buffer_load_dwordx4 v113, s[36:39], s87 offen offset:1024  lds
    buffer_load_dwordx4 v114, s[36:39], s87 offen offset:2048  lds
    buffer_load_dwordx4 v115, s[36:39], s87 offen offset:3072  lds
    s_cmp_lg_u32 s78, 3
    s_cbranch_scc1 L_tk3
    s_and_b32 s101, s76, 3
    s_lshl_b32 s101, s101, 2
    s_add_u32 s101, s101, s72
    s_lshl_b32 s101, s101, 12
    s_and_b32 s88, s78, 1
    s_mul_i32 s88, s88, 65536
    s_add_u32 s101, s101, s88
    s_bfe_u32 s88, s75, 65539
    s_mul_i32 s88, s88, 131072
    s_add_u32 s101, s101, s88
    s_lshr_b32 s88, s76, 2
    s_mul_i32 s88, s88, 458752
    s_add_u32 s101, s101, s88
    v_lshlrev_b32 v236, 3, v211
    s_mov_b32 exec_hi, 0
    buffer_load_dword v238, v236, s[48:51], s101 offen
    s_mov_b64 exec, -1
L_tk3:
    s_waitcnt lgkmcnt(7)
    v_dot2c_f32_bf16 v228, v0, v232
    v_dot2c_f32_bf16 v230, v0, v0
    v_dot2c_f32_bf16 v228, v1, v232
    v_dot2c_f32_bf16 v230, v1, v1
    v_dot2c_f32_bf16 v228, v2, v232
    v_dot2c_f32_bf16 v230, v2, v2
    v_dot2c_f32_bf16 v228, v3, v232
    v_dot2c_f32_bf16 v230, v3, v3
    s_waitcnt lgkmcnt(6)
    v_dot2c_f32_bf16 v228, v4, v232
    v_dot2c_f32_bf16 v230, v4, v4
    v_dot2c_f32_bf16 v228, v5, v232
    v_dot2c_f32_bf16 v230, v5, v5
    v_dot2c_f32_bf16 v228, v6, v232
    v_dot2c_f32_bf16 v230, v6, v6
    v_dot2c_f32_bf16 v228, v7, v232
    v_dot2c_f32_bf16 v230, v7, v7
    s_waitcnt lgkmcnt(5)
    v_dot2c_f32_bf16 v228, v8, v232
    v_dot2c_f32_bf16 v230, v8, v8
    v_dot2c_f32_bf16 v228, v9, v232
    v_dot2c_f32_bf16 v230, v9, v9
    v_dot2c_f32_bf16 v228, v10, v232
    v_dot2c_f32_bf16 v230, v10, v10
    v_dot2c_f32_bf16 v228, v11, v232
    v_dot2c_f32_bf16 v230, v11, v11
    s_waitcnt lgkmcnt(4)
    v_dot2c_f32_bf16 v228, v12, v232
    v_dot2c_f32_bf16 v230, v12, v12
    v_dot2c_f32_bf16 v228, v13, v232
    v_dot2c_f32_bf16 v230, v13, v13
    v_dot2c_f32_bf16 v228, v14, v232
    v_dot2c_f32_bf16 v230, v14, v14
    v_dot2c_f32_bf16 v228, v15, v232
    v_dot2c_f32_bf16 v230, v15, v15
    v_mul_f32 v217, v240, v243
    v_mul_f32 v240, 1124073472, v244
    v_mul_f32 v241, 1124073472, v245
    v_exp_f32 v240, v240
    v_fract_f32 v241, v241
    v_cos_f32 v242, v241
    v_sin_f32 v243, v241
    v_mfma_f32_32x32x16_bf16 v[128:143], v[116:119], v[124:127], 0
    s_waitcnt vmcnt(4)
    ds_read_b128 v[32:35], v204 offset:32768
    ds_read_b128 v[36:39], v205 offset:32768
    ds_read_b128 v[40:43], v206 offset:32768
    ds_read_b128 v[44:47], v207 offset:32768
    s_add_u32 m0, s73, 114688
    s_add_u32 s87, s99, s81
    buffer_load_dwordx4 v112, s[36:39], s87 offen offset:0  lds
    buffer_load_dwordx4 v113, s[36:39], s87 offen offset:1024  lds
    buffer_load_dwordx4 v114, s[36:39], s87 offen offset:2048  lds
    buffer_load_dwordx4 v115, s[36:39], s87 offen offset:3072  lds
    s_waitcnt lgkmcnt(7)
    v_dot2c_f32_bf16 v228, v16, v232
    v_dot2c_f32_bf16 v230, v16, v16
    v_dot2c_f32_bf16 v228, v17, v232
    v_dot2c_f32_bf16 v230, v17, v17
    v_dot2c_f32_bf16 v228, v18, v232
    v_dot2c_f32_bf16 v230, v18, v18
    v_dot2c_f32_bf16 v228, v19, v232
    v_dot2c_f32_bf16 v230, v19, v19
    s_waitcnt lgkmcnt(6)
    v_dot2c_f32_bf16 v228, v20, v232
    v_dot2c_f32_bf16 v230, v20, v20
    v_dot2c_f32_bf16 v228, v21, v232
    v_dot2c_f32_bf16 v230, v21, v21
    v_dot2c_f32_bf16 v228, v22, v232
    v_dot2c_f32_bf16 v230, v22, v22
    v_dot2c_f32_bf16 v228, v23, v232
    v_dot2c_f32_bf16 v230, v23, v23
    s_waitcnt lgkmcnt(5)
    v_dot2c_f32_bf16 v228, v24, v232
    v_dot2c_f32_bf16 v230, v24, v24
    v_dot2c_f32_bf16 v228, v25, v232
    v_dot2c_f32_bf16 v230, v25, v25
    v_dot2c_f32_bf16 v228, v26, v232
    v_dot2c_f32_bf16 v230, v26, v26
    v_dot2c_f32_bf16 v228, v27, v232
    v_dot2c_f32_bf16 v230, v27, v27
    s_waitcnt lgkmcnt(4)
    v_dot2c_f32_bf16 v228, v28, v232
    v_dot2c_f32_bf16 v230, v28, v28
    v_dot2c_f32_bf16 v228, v29, v232
    v_dot2c_f32_bf16 v230, v29, v29
    v_dot2c_f32_bf16 v228, v30, v232
    v_dot2c_f32_bf16 v230, v30, v30
    v_dot2c_f32_bf16 v228, v31, v232
    v_dot2c_f32_bf16 v230, v31, v31
    v_mul_f32 v218, v240, v242
    v_mul_f32 v219, v240, v243
    v_mul_f32 v240, v220, v244
    v_mul_f32 v241, v220, v245
    v_exp_f32 v240, v240
    v_fract_f32 v241, v241
    v_mfma_f32_32x32x16_bf16 v[144:159], v[118:121], v[124:127], 0
    s_waitcnt vmcnt(4)
    ds_read_b128 v[48:51], v204 offset:0
    ds_read_b128 v[52:55], v205 offset:0
    ds_read_b128 v[56:59], v206 offset:0
    ds_read_b128 v[60:63], v207 offset:0
    s_add_u32 m0, s73, 0
    s_add_u32 s87, s100, s81
    buffer_load_dwordx4 v112, s[36:39], s87 offen offset:0  lds
    buffer_load_dwordx4 v113, s[36:39], s87 offen offset:1024  lds
    buffer_load_dwordx4 v114, s[36:39], s87 offen offset:2048  lds
    buffer_load_dwordx4 v115, s[36:39], s87 offen offset:3072  lds
    s_waitcnt lgkmcnt(7)
    v_dot2c_f32_bf16 v228, v32, v232
    v_dot2c_f32_bf16 v230, v32, v32
    v_dot2c_f32_bf16 v228, v33, v232
    v_dot2c_f32_bf16 v230, v33, v33
    v_dot2c_f32_bf16 v228, v34, v232
    v_dot2c_f32_bf16 v230, v34, v34
    v_dot2c_f32_bf16 v228, v35, v232
    v_dot2c_f32_bf16 v230, v35, v35
    s_waitcnt lgkmcnt(6)
    v_dot2c_f32_bf16 v228, v36, v232
    v_dot2c_f32_bf16 v230, v36, v36
    v_dot2c_f32_bf16 v228, v37, v232
    v_dot2c_f32_bf16 v230, v37, v37
    v_dot2c_f32_bf16 v228, v38, v232
    v_dot2c_f32_bf16 v230, v38, v38
    v_dot2c_f32_bf16 v228, v39, v232
    v_dot2c_f32_bf16 v230, v39, v39
    s_waitcnt lgkmcnt(5)
    v_dot2c_f32_bf16 v228, v40, v232
    v_dot2c_f32_bf16 v230, v40, v40
    v_dot2c_f32_bf16 v228, v41, v232
    v_dot2c_f32_bf16 v230, v41, v41
    v_dot2c_f32_bf16 v228, v42, v232
    v_dot2c_f32_bf16 v230, v42, v42
    v_dot2c_f32_bf16 v228, v43, v232
    v_dot2c_f32_bf16 v230, v43, v43
    s_waitcnt lgkmcnt(4)
    v_dot2c_f32_bf16 v228, v44, v232
    v_dot2c_f32_bf16 v230, v44, v44
    v_dot2c_f32_bf16 v228, v45, v232
    v_dot2c_f32_bf16 v230, v45, v45
    v_dot2c_f32_bf16 v228, v46, v232
    v_dot2c_f32_bf16 v230, v46, v46
    v_dot2c_f32_bf16 v228, v47, v232
    v_dot2c_f32_bf16 v230, v47, v47
    v_cos_f32 v242, v241
    v_sin_f32 v243, v241
    v_mul_f32 v220, v240, v242
    v_mul_f32 v221, v240, v243
    v_mul_f32 v240, v222, v244
    v_mul_f32 v241, v222, v245
    v_exp_f32 v240, v240
    v_mfma_f32_32x32x16_bf16 v[160:175], v[120:123], v[124:127], 0
    s_waitcnt vmcnt(4)
    ds_read_b128 v[64:67], v204 offset:49152
    ds_read_b128 v[68:71], v205 offset:49152
    ds_read_b128 v[72:75], v206 offset:49152
    ds_read_b128 v[76:79], v207 offset:49152
    s_add_u32 m0, s73, 131072
    s_add_u32 s87, s99, s82
    buffer_load_dwordx4 v112, s[36:39], s87 offen offset:0  lds
    buffer_load_dwordx4 v113, s[36:39], s87 offen offset:1024  lds
    buffer_load_dwordx4 v114, s[36:39], s87 offen offset:2048  lds
    buffer_load_dwordx4 v115, s[36:39], s87 offen offset:3072  lds
    s_waitcnt lgkmcnt(7)
    v_dot2c_f32_bf16 v228, v48, v232
    v_dot2c_f32_bf16 v230, v48, v48
    v_dot2c_f32_bf16 v228, v49, v232
    v_dot2c_f32_bf16 v230, v49, v49
    v_dot2c_f32_bf16 v228, v50, v232
    v_dot2c_f32_bf16 v230, v50, v50
    v_dot2c_f32_bf16 v228, v51, v232
    v_dot2c_f32_bf16 v230, v51, v51
    s_waitcnt lgkmcnt(6)
    v_dot2c_f32_bf16 v228, v52, v232
    v_dot2c_f32_bf16 v230, v52, v52
    v_dot2c_f32_bf16 v228, v53, v232
    v_dot2c_f32_bf16 v230, v53, v53
    v_dot2c_f32_bf16 v228, v54, v232
    v_dot2c_f32_bf16 v230, v54, v54
    v_dot2c_f32_bf16 v228, v55, v232
    v_dot2c_f32_bf16 v230, v55, v55
    s_waitcnt lgkmcnt(5)
    v_dot2c_f32_bf16 v228, v56, v232
    v_dot2c_f32_bf16 v230, v56, v56
    v_dot2c_f32_bf16 v228, v57, v232
    v_dot2c_f32_bf16 v230, v57, v57
    v_dot2c_f32_bf16 v228, v58, v232
    v_dot2c_f32_bf16 v230, v58, v58
    v_dot2c_f32_bf16 v228, v59, v232
    v_dot2c_f32_bf16 v230, v59, v59
    s_waitcnt lgkmcnt(4)
    v_dot2c_f32_bf16 v228, v60, v232
    v_dot2c_f32_bf16 v230, v60, v60
    v_dot2c_f32_bf16 v228, v61, v232
    v_dot2c_f32_bf16 v230, v61, v61
    v_dot2c_f32_bf16 v228, v62, v232
    v_dot2c_f32_bf16 v230, v62, v62
    v_dot2c_f32_bf16 v228, v63, v232
    v_dot2c_f32_bf16 v230, v63, v63
    v_fract_f32 v241, v241
    v_cos_f32 v242, v241
    v_sin_f32 v243, v241
    v_mul_f32 v222, v240, v242
    v_mul_f32 v223, v240, v243
    v_mul_f32_e64 v240, v246, v246
    v_mfma_f32_32x32x16_bf16 v[176:191], v[122:125], v[124:127], 0
    v_add_u32 v204, 4294901760, v204
    v_add_u32 v205, 4294901760, v205
    v_add_u32 v206, 4294901760, v206
    v_add_u32 v207, 4294901760, v207
    s_waitcnt vmcnt(4)
    ds_read_b128 v[80:83], v204 offset:0
    ds_read_b128 v[84:87], v205 offset:0
    ds_read_b128 v[88:91], v206 offset:0
    ds_read_b128 v[92:95], v207 offset:0
    s_add_u32 m0, s73, 16384
    s_add_u32 s87, s100, s82
    buffer_load_dwordx4 v112, s[36:39], s87 offen offset:0  lds
    buffer_load_dwordx4 v113, s[36:39], s87 offen offset:1024  lds
    buffer_load_dwordx4 v114, s[36:39], s87 offen offset:2048  lds
    buffer_load_dwordx4 v115, s[36:39], s87 offen offset:3072  lds
    s_waitcnt lgkmcnt(7)
    v_dot2c_f32_bf16 v228, v64, v232
    v_dot2c_f32_bf16 v230, v64, v64
    v_dot2c_f32_bf16 v228, v65, v232
    v_dot2c_f32_bf16 v230, v65, v65
    v_dot2c_f32_bf16 v228, v66, v232
    v_dot2c_f32_bf16 v230, v66, v66
    v_dot2c_f32_bf16 v228, v67, v232
    v_dot2c_f32_bf16 v230, v67, v67
    s_waitcnt lgkmcnt(6)
    v_dot2c_f32_bf16 v228, v68, v232
    v_dot2c_f32_bf16 v230, v68, v68
    v_dot2c_f32_bf16 v228, v69, v232
    v_dot2c_f32_bf16 v230, v69, v69
    v_dot2c_f32_bf16 v228, v70, v232
    v_dot2c_f32_bf16 v230, v70, v70
    v_dot2c_f32_bf16 v228, v71, v232
    v_dot2c_f32_bf16 v230, v71, v71
    s_waitcnt lgkmcnt(5)
    v_dot2c_f32_bf16 v228, v72, v232
    v_dot2c_f32_bf16 v230, v72, v72
    v_dot2c_f32_bf16 v228, v73, v232
    v_dot2c_f32_bf16 v230, v73, v73
    v_dot2c_f32_bf16 v228, v74, v232
    v_dot2c_f32_bf16 v230, v74, v74
    v_dot2c_f32_bf16 v228, v75, v232
    v_dot2c_f32_bf16 v230, v75, v75
    s_waitcnt lgkmcnt(4)
    v_dot2c_f32_bf16 v228, v76, v232
    v_dot2c_f32_bf16 v230, v76, v76
    v_dot2c_f32_bf16 v228, v77, v232
    v_dot2c_f32_bf16 v230, v77, v77
    v_dot2c_f32_bf16 v228, v78, v232
    v_dot2c_f32_bf16 v230, v78, v78
    v_dot2c_f32_bf16 v228, v79, v232
    v_dot2c_f32_bf16 v230, v79, v79
    v_fmac_f32 v240, v247, v247
    v_rcp_f32 v240, v240
    v_add_f32 v241, -1.0, v212
    v_mul_f32 v242, v241, v246
    v_fmac_f32 v242, v213, v247
    v_mul_f32 v243, v213, v246
    v_fma_f32 v243, -v241, v247, v243
    v_add_u32 v204, 98304, v204
    v_add_u32 v205, 98304, v205
    v_add_u32 v206, 98304, v206
    v_add_u32 v207, 98304, v207
    s_waitcnt vmcnt(4)
    ds_read_b128 v[96:99], v204 offset:32768
    ds_read_b128 v[100:103], v205 offset:32768
    ds_read_b128 v[104:107], v206 offset:32768
    ds_read_b128 v[108:111], v207 offset:32768
    s_add_u32 m0, s73, 32768
    s_add_u32 s87, s89, s83
    buffer_load_dwordx4 v196, s[44:47], s87 offen offset:0  lds
    buffer_load_dwordx4 v197, s[44:47], s87 offen offset:1024  lds
    buffer_load_dwordx4 v198, s[44:47], s87 offen offset:2048  lds
    buffer_load_dwordx4 v199, s[44:47], s87 offen offset:3072  lds
    s_waitcnt lgkmcnt(7)
    v_dot2c_f32_bf16 v228, v80, v232
    v_dot2c_f32_bf16 v230, v80, v80
    v_dot2c_f32_bf16 v228, v81, v232
    v_dot2c_f32_bf16 v230, v81, v81
    v_dot2c_f32_bf16 v228, v82, v232
    v_dot2c_f32_bf16 v230, v82, v82
    v_dot2c_f32_bf16 v228, v83, v232
    v_dot2c_f32_bf16 v230, v83, v83
    s_waitcnt lgkmcnt(6)
    v_dot2c_f32_bf16 v228, v84, v232
    v_dot2c_f32_bf16 v230, v84, v84
    v_dot2c_f32_bf16 v228, v85, v232
    v_dot2c_f32_bf16 v230, v85, v85
    v_dot2c_f32_bf16 v228, v86, v232
    v_dot2c_f32_bf16 v230, v86, v86
    v_dot2c_f32_bf16 v228, v87, v232
    v_dot2c_f32_bf16 v230, v87, v87
    s_waitcnt lgkmcnt(5)
    v_dot2c_f32_bf16 v228, v88, v232
    v_dot2c_f32_bf16 v230, v88, v88
    v_dot2c_f32_bf16 v228, v89, v232
    v_dot2c_f32_bf16 v230, v89, v89
    v_dot2c_f32_bf16 v228, v90, v232
    v_dot2c_f32_bf16 v230, v90, v90
    v_dot2c_f32_bf16 v228, v91, v232
    v_dot2c_f32_bf16 v230, v91, v91
    s_waitcnt lgkmcnt(4)
    v_dot2c_f32_bf16 v228, v92, v232
    v_dot2c_f32_bf16 v230, v92, v92
    v_dot2c_f32_bf16 v228, v93, v232
    v_dot2c_f32_bf16 v230, v93, v93
    v_dot2c_f32_bf16 v228, v94, v232
    v_dot2c_f32_bf16 v230, v94, v94
    v_dot2c_f32_bf16 v228, v95, v232
    v_dot2c_f32_bf16 v230, v95, v95
    v_mul_f32 v240, 1064697328, v240
    v_mul_f32 v214, v242, v240
    v_mul_f32 v215, v243, v240
    v_add_u32 v252, 2654435761, v252
    v_lshlrev_b32 v254, 16, v254
    v_readfirstlane_b32 s74, v252
    v_mul_f32 v254, 1060205080, v254
    v_add_u32 v204, 4294868992, v204
    v_add_u32 v205, 4294868992, v205
    v_add_u32 v206, 4294868992, v206
    v_add_u32 v207, 4294868992, v207
    s_waitcnt vmcnt(4)
    ds_read_b128 v[112:115], v204 offset:16384
    ds_read_b128 v[116:119], v205 offset:16384
    ds_read_b128 v[120:123], v206 offset:16384
    ds_read_b128 v[124:127], v207 offset:16384
    s_add_u32 m0, s73, 49152
    s_add_u32 s87, s89, s84
    buffer_load_dwordx4 v196, s[44:47], s87 offen offset:0  lds
    buffer_load_dwordx4 v197, s[44:47], s87 offen offset:1024  lds
    buffer_load_dwordx4 v198, s[44:47], s87 offen offset:2048  lds
    buffer_load_dwordx4 v199, s[44:47], s87 offen offset:3072  lds
    s_waitcnt lgkmcnt(7)
    v_dot2c_f32_bf16 v228, v96, v232
    v_dot2c_f32_bf16 v230, v96, v96
    v_dot2c_f32_bf16 v228, v97, v232
    v_dot2c_f32_bf16 v230, v97, v97
    v_dot2c_f32_bf16 v228, v98, v232
    v_dot2c_f32_bf16 v230, v98, v98
    v_dot2c_f32_bf16 v228, v99, v232
    v_dot2c_f32_bf16 v230, v99, v99
    s_waitcnt lgkmcnt(6)
    v_dot2c_f32_bf16 v228, v100, v232
    v_dot2c_f32_bf16 v230, v100, v100
    v_dot2c_f32_bf16 v228, v101, v232
    v_dot2c_f32_bf16 v230, v101, v101
    v_dot2c_f32_bf16 v228, v102, v232
    v_dot2c_f32_bf16 v230, v102, v102
    v_dot2c_f32_bf16 v228, v103, v232
    v_dot2c_f32_bf16 v230, v103, v103
    s_waitcnt lgkmcnt(5)
    v_dot2c_f32_bf16 v228, v104, v232
    v_dot2c_f32_bf16 v230, v104, v104
    v_dot2c_f32_bf16 v228, v105, v232
    v_dot2c_f32_bf16 v230, v105, v105
    v_dot2c_f32_bf16 v228, v106, v232
    v_dot2c_f32_bf16 v230, v106, v106
    v_dot2c_f32_bf16 v228, v107, v232
    v_dot2c_f32_bf16 v230, v107, v107
    s_waitcnt lgkmcnt(4)
    v_dot2c_f32_bf16 v228, v108, v232
    v_dot2c_f32_bf16 v230, v108, v108
    v_dot2c_f32_bf16 v228, v109, v232
    v_dot2c_f32_bf16 v230, v109, v109
    v_dot2c_f32_bf16 v228, v110, v232
    v_dot2c_f32_bf16 v230, v110, v110
    v_dot2c_f32_bf16 v228, v111, v232
    v_dot2c_f32_bf16 v230, v111, v111
    s_waitcnt lgkmcnt(3)
    v_dot2c_f32_bf16 v228, v112, v232
    v_dot2c_f32_bf16 v230, v112, v112
    v_dot2c_f32_bf16 v228, v113, v232
    v_dot2c_f32_bf16 v230, v113, v113
    v_dot2c_f32_bf16 v228, v114, v232
    v_dot2c_f32_bf16 v230, v114, v114
    v_dot2c_f32_bf16 v228, v115, v232
    v_dot2c_f32_bf16 v230, v115, v115
    s_waitcnt lgkmcnt(2)
    v_dot2c_f32_bf16 v228, v116, v232
    v_dot2c_f32_bf16 v230, v116, v116
    v_dot2c_f32_bf16 v228, v117, v232
    v_dot2c_f32_bf16 v230, v117, v117
    v_dot2c_f32_bf16 v228, v118, v232
    v_dot2c_f32_bf16 v230, v118, v118
    v_dot2c_f32_bf16 v228, v119, v232
    v_dot2c_f32_bf16 v230, v119, v119
    s_waitcnt lgkmcnt(1)
    v_dot2c_f32_bf16 v228, v120, v232
    v_dot2c_f32_bf16 v230, v120, v120
    v_dot2c_f32_bf16 v228, v121, v232
    v_dot2c_f32_bf16 v230, v121, v121
    v_dot2c_f32_bf16 v228, v122, v232
    v_dot2c_f32_bf16 v230, v122, v122
    v_dot2c_f32_bf16 v228, v123, v232
    v_dot2c_f32_bf16 v230, v123, v123
    s_waitcnt lgkmcnt(0)
    v_dot2c_f32_bf16 v228, v124, v232
    v_dot2c_f32_bf16 v230, v124, v124
    v_dot2c_f32_bf16 v228, v125, v232
    v_dot2c_f32_bf16 v230, v125, v125
    v_dot2c_f32_bf16 v228, v126, v232
    v_dot2c_f32_bf16 v230, v126, v126
    v_dot2c_f32_bf16 v228, v127, v232
    v_dot2c_f32_bf16 v230, v127, v127
    s_add_u32 s88, s73, 0
    v_subrev_u32 v204, s88, v204
    v_subrev_u32 v205, s88, v205
    v_subrev_u32 v206, s88, v206
    v_mov_b32 v229, v228
    v_mov_b32 v231, v230
    v_subrev_u32 v207, s88, v207
    v_permlane32_swap_b32 v228, v229
    v_permlane32_swap_b32 v230, v231
    v_add_f32 v228, v228, v229
    v_add_f32 v230, v230, v231
    v_mul_f32 v226, 989855744, v228
    v_mul_f32 v230, 989855744, v230
    v_fma_f32 v230, -v226, v226, v230
    v_max_f32 v230, 0, v230
    v_add_f32 v230, 925353388, v230
    v_rsq_f32 v227, v230
    s_nop 0
    v_mul_f32 v234, 1069066811, v227
    v_cvt_pk_bf16_f32 v234, v234, v234
    v_and_b32 v235, 0xffff0000, v234
    v_lshrrev_b32_e64 v234, 16, v234
    v_mul_f32 v233, -v226, v235
    v_dot2_f32_bf16 v240, v0, v234, v233
    v_dot2_f32_bf16 v241, v0, v235, v233
    v_dot2_f32_bf16 v242, v1, v234, v233
    v_dot2_f32_bf16 v243, v1, v235, v233
    s_add_u32 m0, s73, 81920
    s_add_u32 s87, s92, 0
    s_nop 0
    buffer_load_dwordx4 v200, s[48:51], s87 offen offset:0  lds
    buffer_load_dwordx4 v201, s[48:51], s87 offen offset:1024  lds
    v_dot2_f32_bf16 v244, v2, v234, v233
    v_dot2_f32_bf16 v245, v2, v235, v233
    v_dot2_f32_bf16 v246, v3, v234, v233
    v_dot2_f32_bf16 v247, v3, v235, v233
    v_cvt_pk_bf16_f32 v0, v240, v241
    s_cmp_lg_u32 s78, 4
    s_cbranch_scc1 L_tk4
    s_and_b32 s101, s76, 3
    s_lshl_b32 s101, s101, 2
    s_add_u32 s101, s101, s72
    s_mul_i32 s101, s101, 57344
    s_bfe_u32 s88, s75, 65539
    s_mul_i32 s88, s88, 917504
    s_add_u32 s101, s101, s88
    s_lshr_b32 s88, s76, 2
    s_mul_i32 s88, s88, 896
    s_add_u32 s101, s101, s88
    s_add_u32 s101, s101, 512
    v_lshrrev_b32_e64 v236, 6, v211
    v_mul_u32_u24 v236, 3584, v236
    v_bfe_u32 v237, v211, 4, 2
    v_lshl_add_u32 v236, v237, 7, v236
    s_mov_b32 exec_lo, 0x77777777
    s_mov_b32 exec_hi, 0x77777777
    buffer_load_dword v238, v236, s[44:47], s101 offen
    s_mov_b64 exec, -1
L_tk4:
    s_cmp_lg_u32 s78, 5
    s_cbranch_scc1 L_tk5
    s_and_b32 s101, s76, 3
    s_lshl_b32 s101, s101, 2
    s_add_u32 s101, s101, s72
    s_mul_i32 s101, s101, 6144
    s_bfe_u32 s88, s75, 65539
    s_mul_i32 s88, s88, 98304
    s_add_u32 s101, s101, s88
    s_lshr_b32 s88, s76, 2
    s_mul_i32 s88, s88, 458752
    s_add_u32 s101, s101, s88
    s_add_u32 s101, s101, 262144
    v_lshlrev_b32 v236, 3, v211
    s_mov_b32 exec_hi, 0xffff
    buffer_load_dword v238, v236, s[48:51], s101 offen
    s_mov_b64 exec, -1
L_tk5:
    s_nop 0
    v_dot2_f32_bf16 v240, v4, v234, v233
    v_dot2_f32_bf16 v241, v4, v235, v233
    v_cvt_pk_bf16_f32 v1, v242, v243
    v_dot2_f32_bf16 v242, v5, v234, v233
    v_dot2_f32_bf16 v243, v5, v235, v233
    v_cvt_pk_bf16_f32 v2, v244, v245
    v_dot2_f32_bf16 v244, v6, v234, v233
    v_dot2_f32_bf16 v245, v6, v235, v233
    v_cvt_pk_bf16_f32 v3, v246, v247
    v_dot2_f32_bf16 v246, v7, v234, v233
    v_dot2_f32_bf16 v247, v7, v235, v233
    v_cvt_pk_bf16_f32 v4, v240, v241
    v_dot2_f32_bf16 v240, v8, v234, v233
    v_dot2_f32_bf16 v241, v8, v235, v233
    v_cvt_pk_bf16_f32 v5, v242, v243
    v_dot2_f32_bf16 v242, v9, v234, v233
    v_dot2_f32_bf16 v243, v9, v235, v233
    v_cvt_pk_bf16_f32 v6, v244, v245
    v_dot2_f32_bf16 v244, v10, v234, v233
    v_dot2_f32_bf16 v245, v10, v235, v233
    v_cvt_pk_bf16_f32 v7, v246, v247
    v_dot2_f32_bf16 v246, v11, v234, v233
    v_dot2_f32_bf16 v247, v11, v235, v233
    v_cvt_pk_bf16_f32 v8, v240, v241
    v_dot2_f32_bf16 v240, v12, v234, v233
    v_dot2_f32_bf16 v241, v12, v235, v233
    v_cvt_pk_bf16_f32 v9, v242, v243
    v_dot2_f32_bf16 v242, v13, v234, v233
    v_dot2_f32_bf16 v243, v13, v235, v233
    v_cvt_pk_bf16_f32 v10, v244, v245
    buffer_load_dwordx4 v202, s[48:51], s87 offen offset:2048  lds
    buffer_load_dwordx4 v203, s[48:51], s87 offen offset:3072  lds
    v_dot2_f32_bf16 v244, v14, v234, v233
    v_dot2_f32_bf16 v245, v14, v235, v233
    v_cvt_pk_bf16_f32 v11, v246, v247
    v_dot2_f32_bf16 v246, v15, v234, v233
    v_dot2_f32_bf16 v247, v15, v235, v233
    v_cvt_pk_bf16_f32 v12, v240, v241
    v_dot2_f32_bf16 v240, v16, v234, v233
    v_dot2_f32_bf16 v241, v16, v235, v233
    v_cvt_pk_bf16_f32 v13, v242, v243
    v_dot2_f32_bf16 v242, v17, v234, v233
    v_dot2_f32_bf16 v243, v17, v235, v233
    v_cvt_pk_bf16_f32 v14, v244, v245
    v_dot2_f32_bf16 v244, v18, v234, v233
    v_dot2_f32_bf16 v245, v18, v235, v233
    v_cvt_pk_bf16_f32 v15, v246, v247
    v_dot2_f32_bf16 v246, v19, v234, v233
    v_dot2_f32_bf16 v247, v19, v235, v233
    v_cvt_pk_bf16_f32 v16, v240, v241
    v_dot2_f32_bf16 v240, v20, v234, v233
    v_dot2_f32_bf16 v241, v20, v235, v233
    v_cvt_pk_bf16_f32 v17, v242, v243
    v_dot2_f32_bf16 v242, v21, v234, v233
    v_dot2_f32_bf16 v243, v21, v235, v233
    v_cvt_pk_bf16_f32 v18, v244, v245
    v_dot2_f32_bf16 v244, v22, v234, v233
    v_dot2_f32_bf16 v245, v22, v235, v233
    v_cvt_pk_bf16_f32 v19, v246, v247
    v_dot2_f32_bf16 v246, v23, v234, v233
    v_dot2_f32_bf16 v247, v23, v235, v233
    v_cvt_pk_bf16_f32 v20, v240, v241
    v_dot2_f32_bf16 v240, v24, v234, v233
    v_dot2_f32_bf16 v241, v24, v235, v233
    v_cvt_pk_bf16_f32 v21, v242, v243
    s_waitcnt vmcnt(8)
    s_barrier
    ds_read_b64_tr_b16 a[224:225], v208 offset:32768
    ds_read_b64_tr_b16 a[226:227], v208 offset:33280
    ds_read_b64_tr_b16 a[228:229], v208 offset:33024
    ds_read_b64_tr_b16 a[230:231], v208 offset:33536
    ds_read_b64_tr_b16 a[232:233], v208 offset:34816
    ds_read_b64_tr_b16 a[234:235], v208 offset:35328
    ds_read_b64_tr_b16 a[236:237], v208 offset:35072
    ds_read_b64_tr_b16 a[238:239], v208 offset:35584
    ds_read_b64_tr_b16 a[240:241], v208 offset:36864
    ds_read_b64_tr_b16 a[242:243], v208 offset:37376
    ds_read_b64_tr_b16 a[244:245], v208 offset:37120
    ds_read_b64_tr_b16 a[246:247], v208 offset:37632
    v_dot2_f32_bf16 v242, v25, v234, v233
    v_dot2_f32_bf16 v243, v25, v235, v233
    v_cvt_pk_bf16_f32 v22, v244, v245
    v_dot2_f32_bf16 v244, v26, v234, v233
    v_dot2_f32_bf16 v245, v26, v235, v233
    v_cvt_pk_bf16_f32 v23, v246, v247
    v_dot2_f32_bf16 v246, v27, v234, v233
    v_dot2_f32_bf16 v247, v27, v235, v233
    v_cvt_pk_bf16_f32 v24, v240, v241
    v_dot2_f32_bf16 v240, v28, v234, v233
    v_dot2_f32_bf16 v241, v28, v235, v233
    v_cvt_pk_bf16_f32 v25, v242, v243
    v_dot2_f32_bf16 v242, v29, v234, v233
    v_dot2_f32_bf16 v243, v29, v235, v233
    v_cvt_pk_bf16_f32 v26, v244, v245
    v_dot2_f32_bf16 v244, v30, v234, v233
    v_dot2_f32_bf16 v245, v30, v235, v233
    v_cvt_pk_bf16_f32 v27, v246, v247
    v_dot2_f32_bf16 v246, v31, v234, v233
    v_dot2_f32_bf16 v247, v31, v235, v233
    v_cvt_pk_bf16_f32 v28, v240, v241
    v_cvt_pk_bf16_f32 v29, v242, v243
    v_cvt_pk_bf16_f32 v30, v244, v245
    v_cvt_pk_bf16_f32 v31, v246, v247
    s_waitcnt lgkmcnt(10)
    v_mfma_f32_32x32x16_bf16 v[128:143], a[224:227], v[0:3], v[128:143]
    s_waitcnt lgkmcnt(6)
    s_add_u32 m0, s73, 65536
    s_add_u32 s87, s89, s85
    ds_read_b64_tr_b16 a[248:249], v208 offset:38912
    ds_read_b64_tr_b16 a[250:251], v208 offset:39424
    buffer_load_dwordx4 v196, s[44:47], s87 offen offset:0  lds
    v_mfma_f32_32x32x16_bf16 v[144:159], a[228:231], v[0:3], v[144:159]
    ds_read_b64_tr_b16 a[252:253], v208 offset:39168
    ds_read_b64_tr_b16 a[254:255], v208 offset:39680
    buffer_load_dwordx4 v197, s[44:47], s87 offen offset:1024  lds
    v_mfma_f32_32x32x16_bf16 v[128:143], a[232:235], v[4:7], v[128:143]
    s_waitcnt lgkmcnt(6)
    ds_read_b64_tr_b16 a[224:225], v208 offset:40960
    ds_read_b64_tr_b16 a[226:227], v208 offset:41472
    buffer_load_dwordx4 v198, s[44:47], s87 offen offset:2048  lds
    v_mfma_f32_32x32x16_bf16 v[144:159], a[236:239], v[4:7], v[144:159]
    ds_read_b64_tr_b16 a[228:229], v208 offset:41216
    ds_read_b64_tr_b16 a[230:231], v208 offset:41728
    v_mfma_f32_32x32x16_bf16 v[128:143], a[240:243], v[8:11], v[128:143]
    s_waitcnt lgkmcnt(6)
    ds_read_b64_tr_b16 a[232:233], v208 offset:43008
    ds_read_b64_tr_b16 a[234:235], v208 offset:43520
    buffer_load_dwordx4 v199, s[44:47], s87 offen offset:3072  lds
    v_mfma_f32_32x32x16_bf16 v[144:159], a[244:247], v[8:11], v[144:159]
    s_add_u32 m0, s73, 98304
    s_add_u32 s87, s92, 65536
    ds_read_b64_tr_b16 a[236:237], v208 offset:43264
    ds_read_b64_tr_b16 a[238:239], v208 offset:43776
    buffer_load_dwordx4 v200, s[48:51], s87 offen offset:0  lds
    v_mfma_f32_32x32x16_bf16 v[128:143], a[248:251], v[12:15], v[128:143]
    s_waitcnt lgkmcnt(6)
    ds_read_b64_tr_b16 a[240:241], v208 offset:45056
    ds_read_b64_tr_b16 a[242:243], v208 offset:45568
    buffer_load_dwordx4 v201, s[48:51], s87 offen offset:1024  lds
    v_dot2_f32_bf16 v240, v32, v234, v233
    v_dot2_f32_bf16 v241, v32, v235, v233
    v_dot2_f32_bf16 v242, v33, v234, v233
    v_dot2_f32_bf16 v243, v33, v235, v233
    v_dot2_f32_bf16 v244, v34, v234, v233
    v_dot2_f32_bf16 v245, v34, v235, v233
    v_dot2_f32_bf16 v246, v35, v234, v233
    v_dot2_f32_bf16 v247, v35, v235, v233
    v_cvt_pk_bf16_f32 v32, v240, v241
    v_dot2_f32_bf16 v240, v36, v234, v233
    v_dot2_f32_bf16 v241, v36, v235, v233
    v_cvt_pk_bf16_f32 v33, v242, v243
    v_dot2_f32_bf16 v242, v37, v234, v233
    v_dot2_f32_bf16 v243, v37, v235, v233
    v_cvt_pk_bf16_f32 v34, v244, v245
    v_dot2_f32_bf16 v244, v38, v234, v233
    v_dot2_f32_bf16 v245, v38, v235, v233
    v_cvt_pk_bf16_f32 v35, v246, v247
    v_dot2_f32_bf16 v246, v39, v234, v233
    v_dot2_f32_bf16 v247, v39, v235, v233
    v_cvt_pk_bf16_f32 v36, v240, v241
    v_dot2_f32_bf16 v240, v40, v234, v233
    v_dot2_f32_bf16 v241, v40, v235, v233
    v_cvt_pk_bf16_f32 v37, v242, v243
    v_dot2_f32_bf16 v242, v41, v234, v233
    v_dot2_f32_bf16 v243, v41, v235, v233
    v_cvt_pk_bf16_f32 v38, v244, v245
    v_dot2_f32_bf16 v244, v42, v234, v233
    v_dot2_f32_bf16 v245, v42, v235, v233
    v_cvt_pk_bf16_f32 v39, v246, v247
    v_dot2_f32_bf16 v246, v43, v234, v233
    v_dot2_f32_bf16 v247, v43, v235, v233
    v_cvt_pk_bf16_f32 v40, v240, v241
    v_dot2_f32_bf16 v240, v44, v234, v233
    v_dot2_f32_bf16 v241, v44, v235, v233
    v_cvt_pk_bf16_f32 v41, v242, v243
    v_dot2_f32_bf16 v242, v45, v234, v233
    v_dot2_f32_bf16 v243, v45, v235, v233
    v_cvt_pk_bf16_f32 v42, v244, v245
    v_dot2_f32_bf16 v244, v46, v234, v233
    v_dot2_f32_bf16 v245, v46, v235, v233
    v_cvt_pk_bf16_f32 v43, v246, v247
    v_dot2_f32_bf16 v246, v47, v234, v233
    v_dot2_f32_bf16 v247, v47, v235, v233
    v_cvt_pk_bf16_f32 v44, v240, v241
    v_dot2_f32_bf16 v240, v48, v234, v233
    v_dot2_f32_bf16 v241, v48, v235, v233
    v_cvt_pk_bf16_f32 v45, v242, v243
    v_dot2_f32_bf16 v242, v49, v234, v233
    v_dot2_f32_bf16 v243, v49, v235, v233
    v_cvt_pk_bf16_f32 v46, v244, v245
    v_dot2_f32_bf16 v244, v50, v234, v233
    v_dot2_f32_bf16 v245, v50, v235, v233
    v_cvt_pk_bf16_f32 v47, v246, v247
    v_dot2_f32_bf16 v246, v51, v234, v233
    v_dot2_f32_bf16 v247, v51, v235, v233
    v_cvt_pk_bf16_f32 v48, v240, v241
    v_dot2_f32_bf16 v240, v52, v234, v233
    v_dot2_f32_bf16 v241, v52, v235, v233
    v_cvt_pk_bf16_f32 v49, v242, v243
    v_dot2_f32_bf16 v242, v53, v234, v233
    v_dot2_f32_bf16 v243, v53, v235, v233
    v_cvt_pk_bf16_f32 v50, v244, v245
    v_dot2_f32_bf16 v244, v54, v234, v233
    v_dot2_f32_bf16 v245, v54, v235, v233
    v_cvt_pk_bf16_f32 v51, v246, v247
    v_dot2_f32_bf16 v246, v55, v234, v233
    v_dot2_f32_bf16 v247, v55, v235, v233
    v_cvt_pk_bf16_f32 v52, v240, v241
    v_dot2_f32_bf16 v240, v56, v234, v233
    v_dot2_f32_bf16 v241, v56, v235, v233
    v_cvt_pk_bf16_f32 v53, v242, v243
    v_dot2_f32_bf16 v242, v57, v234, v233
    v_dot2_f32_bf16 v243, v57, v235, v233
    v_cvt_pk_bf16_f32 v54, v244, v245
    v_dot2_f32_bf16 v244, v58, v234, v233
    v_dot2_f32_bf16 v245, v58, v235, v233
    v_cvt_pk_bf16_f32 v55, v246, v247
    v_dot2_f32_bf16 v246, v59, v234, v233
    v_dot2_f32_bf16 v247, v59, v235, v233
    v_cvt_pk_bf16_f32 v56, v240, v241
    v_dot2_f32_bf16 v240, v60, v234, v233
    v_dot2_f32_bf16 v241, v60, v235, v233
    v_cvt_pk_bf16_f32 v57, v242, v243
    v_dot2_f32_bf16 v242, v61, v234, v233
    v_dot2_f32_bf16 v243, v61, v235, v233
    v_cvt_pk_bf16_f32 v58, v244, v245
    v_dot2_f32_bf16 v244, v62, v234, v233
    v_dot2_f32_bf16 v245, v62, v235, v233
    v_cvt_pk_bf16_f32 v59, v246, v247
    v_dot2_f32_bf16 v246, v63, v234, v233
    v_dot2_f32_bf16 v247, v63, v235, v233
    v_cvt_pk_bf16_f32 v60, v240, v241
    v_cvt_pk_bf16_f32 v61, v242, v243
    v_cvt_pk_bf16_f32 v62, v244, v245
    v_cvt_pk_bf16_f32 v63, v246, v247
    v_mfma_f32_32x32x16_bf16 v[144:159], a[252:255], v[12:15], v[144:159]
    ds_read_b64_tr_b16 a[244:245], v208 offset:45312
    ds_read_b64_tr_b16 a[246:247], v208 offset:45824
    v_mfma_f32_32x32x16_bf16 v[128:143], a[224:227], v[16:19], v[128:143]
    s_waitcnt lgkmcnt(6)
    ds_read_b64_tr_b16 a[248:249], v208 offset:47104
    ds_read_b64_tr_b16 a[250:251], v208 offset:47616
    buffer_load_dwordx4 v202, s[48:51], s87 offen offset:2048  lds
    v_mfma_f32_32x32x16_bf16 v[144:159], a[228:231], v[16:19], v[144:159]
    ds_read_b64_tr_b16 a[252:253], v208 offset:47360
    ds_read_b64_tr_b16 a[254:255], v208 offset:47872
    buffer_load_dwordx4 v203, s[48:51], s87 offen offset:3072  lds
    v_mfma_f32_32x32x16_bf16 v[128:143], a[232:235], v[20:23], v[128:143]
    s_waitcnt vmcnt(8) lgkmcnt(6)
    s_barrier
    ds_read_b64_tr_b16 a[224:225], v208 offset:49152
    ds_read_b64_tr_b16 a[226:227], v208 offset:49664
    v_mfma_f32_32x32x16_bf16 v[144:159], a[236:239], v[20:23], v[144:159]
    s_add_u32 m0, s73, 0
    s_add_u32 s87, s89, s86
    ds_read_b64_tr_b16 a[228:229], v208 offset:49408
    ds_read_b64_tr_b16 a[230:231], v208 offset:49920
    buffer_load_dwordx4 v196, s[44:47], s87 offen offset:0  lds
    ds_read_b64_tr_b16 a[0:1], v210 offset:0
    v_mfma_f32_32x32x16_bf16 v[128:143], a[240:243], v[24:27], v[128:143]
    s_waitcnt lgkmcnt(7)
    ds_read_b64_tr_b16 a[232:233], v208 offset:51200
    ds_read_b64_tr_b16 a[234:235], v208 offset:51712
    buffer_load_dwordx4 v197, s[44:47], s87 offen offset:1024  lds
    ds_read_b64_tr_b16 a[2:3], v210 offset:1024
    v_mfma_f32_32x32x16_bf16 v[144:159], a[244:247], v[24:27], v[144:159]
    ds_read_b64_tr_b16 a[236:237], v208 offset:51456
    ds_read_b64_tr_b16 a[238:239], v208 offset:51968
    buffer_load_dwordx4 v198, s[44:47], s87 offen offset:2048  lds
    ds_read_b64_tr_b16 a[4:5], v210 offset:256
    ds_read_b64_tr_b16 a[6:7], v210 offset:1280
    v_mfma_f32_32x32x16_bf16 v[128:143], a[248:251], v[28:31], v[128:143]
    s_waitcnt lgkmcnt(10)
    ds_read_b64_tr_b16 a[240:241], v208 offset:53248
    ds_read_b64_tr_b16 a[242:243], v208 offset:53760
    s_cmp_lg_u32 s78, 6
    s_cbranch_scc1 L_tk6
    s_lshl_b32 s101, s76, 15
    s_bfe_u32 s88, s75, 65539
    s_mul_i32 s88, s88, 16384
    s_add_u32 s101, s101, s88
    s_and_b32 s88, s72, 1
    s_lshl_b32 s88, s88, 13
    s_add_u32 s101, s101, s88
    v_lshlrev_b32 v236, 3, v211
    s_lshr_b32 s88, s72, 1
    s_lshl_b32 s88, s88, 12
    s_add_u32 s101, s101, s88
    s_mov_b32 exec_hi, 0
    buffer_load_dword v238, v236, s[52:55], s101 offen
    buffer_load_dword v238, v236, s[56:59], s101 offen
    s_mov_b64 exec, -1
L_tk6:
    v_mfma_f32_32x32x16_bf16 v[144:159], a[252:255], v[28:31], v[144:159]
    ds_read_b64_tr_b16 a[244:245], v208 offset:53504
    ds_read_b64_tr_b16 a[246:247], v208 offset:54016
    buffer_load_dwordx4 v199, s[44:47], s87 offen offset:3072  lds
    ds_read_b64_tr_b16 a[8:9], v210 offset:2048
    v_mfma_f32_32x32x16_bf16 v[128:143], a[224:227], v[32:35], v[128:143]
    s_waitcnt lgkmcnt(10)
    s_add_u32 m0, s73, 114688
    s_add_u32 s87, s92, 131072
    ds_read_b64_tr_b16 a[248:249], v208 offset:55296
    ds_read_b64_tr_b16 a[250:251], v208 offset:55808
    buffer_load_dwordx4 v200, s[48:51], s87 offen offset:0  lds
    v_mfma_f32_32x32x16_bf16 v[144:159], a[228:231], v[32:35], v[144:159]
    ds_read_b64_tr_b16 a[252:253], v208 offset:55552
    ds_read_b64_tr_b16 a[254:255], v208 offset:56064
    buffer_load_dwordx4 v201, s[48:51], s87 offen offset:1024  lds
    ds_read_b64_tr_b16 a[10:11], v210 offset:3072
    ds_read_b64_tr_b16 a[12:13], v210 offset:2304
    v_mfma_f32_32x32x16_bf16 v[128:143], a[232:235], v[36:39], v[128:143]
    s_waitcnt lgkmcnt(9)
    ds_read_b64_tr_b16 a[224:225], v208 offset:57344
    ds_read_b64_tr_b16 a[226:227], v208 offset:57856
    ds_read_b64_tr_b16 a[14:15], v210 offset:3328
    ds_read_b64_tr_b16 a[16:17], v210 offset:8192
    ds_read_b64_tr_b16 a[18:19], v210 offset:9216
    ds_read_b64_tr_b16 a[20:21], v210 offset:8448
    v_mfma_f32_32x32x16_bf16 v[144:159], a[236:239], v[36:39], v[144:159]
    ds_read_b64_tr_b16 a[228:229], v208 offset:57600
    ds_read_b64_tr_b16 a[230:231], v208 offset:58112
    buffer_load_dwordx4 v202, s[48:51], s87 offen offset:2048  lds
    ds_read_b64_tr_b16 a[22:23], v210 offset:9472
    ds_read_b64_tr_b16 a[24:25], v210 offset:10240
    v_mfma_f32_32x32x16_bf16 v[128:143], a[240:243], v[40:43], v[128:143]
    s_waitcnt lgkmcnt(14)
    ds_read_b64_tr_b16 a[232:233], v208 offset:59392
    ds_read_b64_tr_b16 a[234:235], v208 offset:59904
    buffer_load_dwordx4 v203, s[48:51], s87 offen offset:3072  lds
    ds_read_b64_tr_b16 a[26:27], v210 offset:11264
    v_mfma_f32_32x32x16_bf16 v[144:159], a[244:247], v[40:43], v[144:159]
    s_nop 0
    s_add_u32 m0, s73, 131072
    s_add_u32 s87, s92, 196608
    ds_read_b64_tr_b16 a[236:237], v208 offset:59648
    ds_read_b64_tr_b16 a[238:239], v208 offset:60160
    buffer_load_dwordx4 v200, s[48:51], s87 offen offset:0  lds
    ds_read_b64_tr_b16 a[28:29], v210 offset:10496
    v_mfma_f32_32x32x16_bf16 v[128:143], a[248:251], v[44:47], v[128:143]
    s_waitcnt lgkmcnt(14)
    s_nop 0
    ds_read_b64_tr_b16 a[240:241], v208 offset:61440
    ds_read_b64_tr_b16 a[242:243], v208 offset:61952
    v_dot2_f32_bf16 v240, v64, v234, v233
    v_dot2_f32_bf16 v241, v64, v235, v233
    v_dot2_f32_bf16 v242, v65, v234, v233
    v_dot2_f32_bf16 v243, v65, v235, v233
    v_dot2_f32_bf16 v244, v66, v234, v233
    v_dot2_f32_bf16 v245, v66, v235, v233
    v_dot2_f32_bf16 v246, v67, v234, v233
    v_dot2_f32_bf16 v247, v67, v235, v233
    v_cvt_pk_bf16_f32 v64, v240, v241
    v_dot2_f32_bf16 v240, v68, v234, v233
    v_dot2_f32_bf16 v241, v68, v235, v233
    v_cvt_pk_bf16_f32 v65, v242, v243
    v_dot2_f32_bf16 v242, v69, v234, v233
    v_dot2_f32_bf16 v243, v69, v235, v233
    v_cvt_pk_bf16_f32 v66, v244, v245
    v_dot2_f32_bf16 v244, v70, v234, v233
    v_dot2_f32_bf16 v245, v70, v235, v233
    v_cvt_pk_bf16_f32 v67, v246, v247
    v_dot2_f32_bf16 v246, v71, v234, v233
    v_dot2_f32_bf16 v247, v71, v235, v233
    v_cvt_pk_bf16_f32 v68, v240, v241
    v_dot2_f32_bf16 v240, v72, v234, v233
    v_dot2_f32_bf16 v241, v72, v235, v233
    v_cvt_pk_bf16_f32 v69, v242, v243
    v_dot2_f32_bf16 v242, v73, v234, v233
    v_dot2_f32_bf16 v243, v73, v235, v233
    v_cvt_pk_bf16_f32 v70, v244, v245
    v_dot2_f32_bf16 v244, v74, v234, v233
    v_dot2_f32_bf16 v245, v74, v235, v233
    v_cvt_pk_bf16_f32 v71, v246, v247
    v_dot2_f32_bf16 v246, v75, v234, v233
    v_dot2_f32_bf16 v247, v75, v235, v233
    v_cvt_pk_bf16_f32 v72, v240, v241
    v_dot2_f32_bf16 v240, v76, v234, v233
    v_dot2_f32_bf16 v241, v76, v235, v233
    v_cvt_pk_bf16_f32 v73, v242, v243
    v_dot2_f32_bf16 v242, v77, v234, v233
    v_dot2_f32_bf16 v243, v77, v235, v233
    v_cvt_pk_bf16_f32 v74, v244, v245
    v_dot2_f32_bf16 v244, v78, v234, v233
    v_dot2_f32_bf16 v245, v78, v235, v233
    v_cvt_pk_bf16_f32 v75, v246, v247
    v_dot2_f32_bf16 v246, v79, v234, v233
    v_dot2_f32_bf16 v247, v79, v235, v233
    v_cvt_pk_bf16_f32 v76, v240, v241
    v_dot2_f32_bf16 v240, v80, v234, v233
    v_dot2_f32_bf16 v241, v80, v235, v233
    v_cvt_pk_bf16_f32 v77, v242, v243
    v_dot2_f32_bf16 v242, v81, v234, v233
    v_dot2_f32_bf16 v243, v81, v235, v233
    v_cvt_pk_bf16_f32 v78, v244, v245
    v_dot2_f32_bf16 v244, v82, v234, v233
    v_dot2_f32_bf16 v245, v82, v235, v233
    v_cvt_pk_bf16_f32 v79, v246, v247
    v_dot2_f32_bf16 v246, v83, v234, v233
    v_dot2_f32_bf16 v247, v83, v235, v233
    v_cvt_pk_bf16_f32 v80, v240, v241
    v_dot2_f32_bf16 v240, v84, v234, v233
    v_dot2_f32_bf16 v241, v84, v235, v233
    v_cvt_pk_bf16_f32 v81, v242, v243
    v_dot2_f32_bf16 v242, v85, v234, v233
    v_dot2_f32_bf16 v243, v85, v235, v233
    v_cvt_pk_bf16_f32 v82, v244, v245
    v_dot2_f32_bf16 v244, v86, v234, v233
    v_dot2_f32_bf16 v245, v86, v235, v233
    v_cvt_pk_bf16_f32 v83, v246, v247
    v_dot2_f32_bf16 v246, v87, v234, v233
    v_dot2_f32_bf16 v247, v87, v235, v233
    v_cvt_pk_bf16_f32 v84, v240, v241
    v_dot2_f32_bf16 v240, v88, v234, v233
    v_dot2_f32_bf16 v241, v88, v235, v233
    v_cvt_pk_bf16_f32 v85, v242, v243
    v_dot2_f32_bf16 v242, v89, v234, v233
    v_dot2_f32_bf16 v243, v89, v235, v233
    v_cvt_pk_bf16_f32 v86, v244, v245
    v_dot2_f32_bf16 v244, v90, v234, v233
    v_dot2_f32_bf16 v245, v90, v235, v233
    v_cvt_pk_bf16_f32 v87, v246, v247
    v_dot2_f32_bf16 v246, v91, v234, v233
    v_dot2_f32_bf16 v247, v91, v235, v233
    v_cvt_pk_bf16_f32 v88, v240, v241
    v_dot2_f32_bf16 v240, v92, v234, v233
    v_dot2_f32_bf16 v241, v92, v235, v233
    v_cvt_pk_bf16_f32 v89, v242, v243
    v_dot2_f32_bf16 v242, v93, v234, v233
    v_dot2_f32_bf16 v243, v93, v235, v233
    v_cvt_pk_bf16_f32 v90, v244, v245
    v_dot2_f32_bf16 v244, v94, v234, v233
    v_dot2_f32_bf16 v245, v94, v235, v233
    v_cvt_pk_bf16_f32 v91, v246, v247
    v_dot2_f32_bf16 v246, v95, v234, v233
    v_dot2_f32_bf16 v247, v95, v235, v233
    v_cvt_pk_bf16_f32 v92, v240, v241
    v_cvt_pk_bf16_f32 v93, v242, v243
    v_cvt_pk_bf16_f32 v94, v244, v245
    v_cvt_pk_bf16_f32 v95, v246, v247
    v_mfma_f32_32x32x16_bf16 v[144:159], a[252:255], v[44:47], v[144:159]
    ds_read_b64_tr_b16 a[244:245], v208 offset:61696
    ds_read_b64_tr_b16 a[246:247], v208 offset:62208
    buffer_load_dwordx4 v201, s[48:51], s87 offen offset:1024  lds
    ds_read_b64_tr_b16 a[30:31], v210 offset:11520
    v_mfma_f32_32x32x16_bf16 v[128:143], a[224:227], v[48:51], v[128:143]
    s_waitcnt lgkmcnt(9)
    ds_read_b64_tr_b16 a[248:249], v208 offset:63488
    ds_read_b64_tr_b16 a[250:251], v208 offset:64000
    buffer_load_dwordx4 v202, s[48:51], s87 offen offset:2048  lds
    v_mfma_f32_32x32x16_bf16 v[144:159], a[228:231], v[48:51], v[144:159]
    ds_read_b64_tr_b16 a[252:253], v208 offset:63744
    ds_read_b64_tr_b16 a[254:255], v208 offset:64256
    buffer_load_dwordx4 v203, s[48:51], s87 offen offset:3072  lds
    v_mfma_f32_32x32x16_bf16 v[128:143], a[232:235], v[52:55], v[128:143]
    s_waitcnt vmcnt(12) lgkmcnt(4)
    s_barrier
    ds_read_b64_tr_b16 a[224:225], v209 offset:0
    ds_read_b64_tr_b16 a[226:227], v209 offset:512
    v_mfma_f32_32x32x16_bf16 v[144:159], a[236:239], v[52:55], v[144:159]
    s_nop 0
    s_add_u32 m0, s73, 81920
    s_add_u32 s87, s92, 262144
    ds_read_b64_tr_b16 a[228:229], v209 offset:256
    ds_read_b64_tr_b16 a[230:231], v209 offset:768
    buffer_load_dwordx4 v200, s[48:51], s87 offen offset:0  lds
    ds_read_b64_tr_b16 a[32:33], v210 offset:16384
    v_mfma_f32_32x32x16_bf16 v[128:143], a[240:243], v[56:59], v[128:143]
    s_waitcnt lgkmcnt(7)
    ds_read_b64_tr_b16 a[232:233], v209 offset:2048
    ds_read_b64_tr_b16 a[234:235], v209 offset:2560
    buffer_load_dwordx4 v201, s[48:51], s87 offen offset:1024  lds
    ds_read_b64_tr_b16 a[34:35], v210 offset:17408
    v_mfma_f32_32x32x16_bf16 v[144:159], a[244:247], v[56:59], v[144:159]
    ds_read_b64_tr_b16 a[236:237], v209 offset:2304
    ds_read_b64_tr_b16 a[238:239], v209 offset:2816
    buffer_load_dwordx4 v202, s[48:51], s87 offen offset:2048  lds
    ds_read_b64_tr_b16 a[36:37], v210 offset:16640
    ds_read_b64_tr_b16 a[38:39], v210 offset:17664
    v_mfma_f32_32x32x16_bf16 v[128:143], a[248:251], v[60:63], v[128:143]
    s_waitcnt lgkmcnt(10)
    ds_read_b64_tr_b16 a[240:241], v209 offset:4096
    ds_read_b64_tr_b16 a[242:243], v209 offset:4608
    s_cmp_lg_u32 s78, 7
    s_cbranch_scc1 L_tk7
    s_lshl_b32 s101, s76, 15
    s_bfe_u32 s88, s75, 65539
    s_mul_i32 s88, s88, 16384
    s_add_u32 s101, s101, s88
    s_and_b32 s88, s72, 1
    s_lshl_b32 s88, s88, 13
    s_add_u32 s101, s101, s88
    v_lshlrev_b32 v236, 3, v211
    buffer_load_dword v238, v236, s[40:43], s101 offen
    s_mov_b64 exec, -1
L_tk7:
    v_mfma_f32_32x32x16_bf16 v[144:159], a[252:255], v[60:63], v[144:159]
    ds_read_b64_tr_b16 a[244:245], v209 offset:4352
    ds_read_b64_tr_b16 a[246:247], v209 offset:4864
    buffer_load_dwordx4 v203, s[48:51], s87 offen offset:3072  lds
    ds_read_b64_tr_b16 a[40:41], v210 offset:18432
    v_mfma_f32_32x32x16_bf16 v[128:143], a[224:227], v[64:67], v[128:143]
    s_waitcnt lgkmcnt(10)
    s_add_u32 m0, s73, 16384
    s_add_u32 s87, s90, s83
    ds_read_b64_tr_b16 a[248:249], v209 offset:6144
    ds_read_b64_tr_b16 a[250:251], v209 offset:6656
    buffer_load_dwordx4 v196, s[44:47], s87 offen offset:0  lds
    v_mfma_f32_32x32x16_bf16 v[144:159], a[228:231], v[64:67], v[144:159]
    ds_read_b64_tr_b16 a[252:253], v209 offset:6400
    ds_read_b64_tr_b16 a[254:255], v209 offset:6912
    buffer_load_dwordx4 v197, s[44:47], s87 offen offset:1024  lds
    ds_read_b64_tr_b16 a[42:43], v210 offset:19456
    ds_read_b64_tr_b16 a[44:45], v210 offset:18688
    v_mfma_f32_32x32x16_bf16 v[128:143], a[232:235], v[68:71], v[128:143]
    s_waitcnt lgkmcnt(9)
    ds_read_b64_tr_b16 a[224:225], v209 offset:8192
    ds_read_b64_tr_b16 a[226:227], v209 offset:8704
    ds_read_b64_tr_b16 a[46:47], v210 offset:19712
    ds_read_b64_tr_b16 a[48:49], v210 offset:24576
    ds_read_b64_tr_b16 a[50:51], v210 offset:25600
    ds_read_b64_tr_b16 a[52:53], v210 offset:24832
    v_mfma_f32_32x32x16_bf16 v[144:159], a[236:239], v[68:71], v[144:159]
    ds_read_b64_tr_b16 a[228:229], v209 offset:8448
    ds_read_b64_tr_b16 a[230:231], v209 offset:8960
    buffer_load_dwordx4 v198, s[44:47], s87 offen offset:2048  lds
    ds_read_b64_tr_b16 a[54:55], v210 offset:25856
    ds_read_b64_tr_b16 a[56:57], v210 offset:26624
    v_mfma_f32_32x32x16_bf16 v[128:143], a[240:243], v[72:75], v[128:143]
    s_waitcnt lgkmcnt(14)
    ds_read_b64_tr_b16 a[232:233], v209 offset:10240
    ds_read_b64_tr_b16 a[234:235], v209 offset:10752
    buffer_load_dwordx4 v199, s[44:47], s87 offen offset:3072  lds
    ds_read_b64_tr_b16 a[58:59], v210 offset:27648
    v_mfma_f32_32x32x16_bf16 v[144:159], a[244:247], v[72:75], v[144:159]
    s_add_u32 m0, s73, 32768
    s_add_u32 s87, s90, s84
    ds_read_b64_tr_b16 a[236:237], v209 offset:10496
    ds_read_b64_tr_b16 a[238:239], v209 offset:11008
    buffer_load_dwordx4 v196, s[44:47], s87 offen offset:0  lds
    ds_read_b64_tr_b16 a[60:61], v210 offset:26880
    v_mfma_f32_32x32x16_bf16 v[128:143], a[248:251], v[76:79], v[128:143]
    s_waitcnt lgkmcnt(14)
    s_nop 0
    ds_read_b64_tr_b16 a[240:241], v209 offset:12288
    ds_read_b64_tr_b16 a[242:243], v209 offset:12800
    v_dot2_f32_bf16 v240, v96, v234, v233
    v_dot2_f32_bf16 v241, v96, v235, v233
    v_dot2_f32_bf16 v242, v97, v234, v233
    v_dot2_f32_bf16 v243, v97, v235, v233
    v_dot2_f32_bf16 v244, v98, v234, v233
    v_dot2_f32_bf16 v245, v98, v235, v233
    v_dot2_f32_bf16 v246, v99, v234, v233
    v_dot2_f32_bf16 v247, v99, v235, v233
    v_cvt_pk_bf16_f32 v96, v240, v241
    v_dot2_f32_bf16 v240, v100, v234, v233
    v_dot2_f32_bf16 v241, v100, v235, v233
    v_cvt_pk_bf16_f32 v97, v242, v243
    v_dot2_f32_bf16 v242, v101, v234, v233
    v_dot2_f32_bf16 v243, v101, v235, v233
    v_cvt_pk_bf16_f32 v98, v244, v245
    v_dot2_f32_bf16 v244, v102, v234, v233
    v_dot2_f32_bf16 v245, v102, v235, v233
    v_cvt_pk_bf16_f32 v99, v246, v247
    v_dot2_f32_bf16 v246, v103, v234, v233
    v_dot2_f32_bf16 v247, v103, v235, v233
    v_cvt_pk_bf16_f32 v100, v240, v241
    v_dot2_f32_bf16 v240, v104, v234, v233
    v_dot2_f32_bf16 v241, v104, v235, v233
    v_cvt_pk_bf16_f32 v101, v242, v243
    v_dot2_f32_bf16 v242, v105, v234, v233
    v_dot2_f32_bf16 v243, v105, v235, v233
    v_cvt_pk_bf16_f32 v102, v244, v245
    v_dot2_f32_bf16 v244, v106, v234, v233
    v_dot2_f32_bf16 v245, v106, v235, v233
    v_cvt_pk_bf16_f32 v103, v246, v247
    v_dot2_f32_bf16 v246, v107, v234, v233
    v_dot2_f32_bf16 v247, v107, v235, v233
    v_cvt_pk_bf16_f32 v104, v240, v241
    v_dot2_f32_bf16 v240, v108, v234, v233
    v_dot2_f32_bf16 v241, v108, v235, v233
    v_cvt_pk_bf16_f32 v105, v242, v243
    v_dot2_f32_bf16 v242, v109, v234, v233
    v_dot2_f32_bf16 v243, v109, v235, v233
    v_cvt_pk_bf16_f32 v106, v244, v245
    v_dot2_f32_bf16 v244, v110, v234, v233
    v_dot2_f32_bf16 v245, v110, v235, v233
    v_cvt_pk_bf16_f32 v107, v246, v247
    v_dot2_f32_bf16 v246, v111, v234, v233
    v_dot2_f32_bf16 v247, v111, v235, v233
    v_cvt_pk_bf16_f32 v108, v240, v241
    v_dot2_f32_bf16 v240, v112, v234, v233
    v_dot2_f32_bf16 v241, v112, v235, v233
    v_cvt_pk_bf16_f32 v109, v242, v243
    v_dot2_f32_bf16 v242, v113, v234, v233
    v_dot2_f32_bf16 v243, v113, v235, v233
    v_cvt_pk_bf16_f32 v110, v244, v245
    v_dot2_f32_bf16 v244, v114, v234, v233
    v_dot2_f32_bf16 v245, v114, v235, v233
    v_cvt_pk_bf16_f32 v111, v246, v247
    v_dot2_f32_bf16 v246, v115, v234, v233
    v_dot2_f32_bf16 v247, v115, v235, v233
    v_cvt_pk_bf16_f32 v112, v240, v241
    v_dot2_f32_bf16 v240, v116, v234, v233
    v_dot2_f32_bf16 v241, v116, v235, v233
    v_cvt_pk_bf16_f32 v113, v242, v243
    v_dot2_f32_bf16 v242, v117, v234, v233
    v_dot2_f32_bf16 v243, v117, v235, v233
    v_cvt_pk_bf16_f32 v114, v244, v245
    v_dot2_f32_bf16 v244, v118, v234, v233
    v_dot2_f32_bf16 v245, v118, v235, v233
    v_cvt_pk_bf16_f32 v115, v246, v247
    v_dot2_f32_bf16 v246, v119, v234, v233
    v_dot2_f32_bf16 v247, v119, v235, v233
    v_cvt_pk_bf16_f32 v116, v240, v241
    v_dot2_f32_bf16 v240, v120, v234, v233
    v_dot2_f32_bf16 v241, v120, v235, v233
    v_cvt_pk_bf16_f32 v117, v242, v243
    v_dot2_f32_bf16 v242, v121, v234, v233
    v_dot2_f32_bf16 v243, v121, v235, v233
    v_cvt_pk_bf16_f32 v118, v244, v245
    v_dot2_f32_bf16 v244, v122, v234, v233
    v_dot2_f32_bf16 v245, v122, v235, v233
    v_cvt_pk_bf16_f32 v119, v246, v247
    v_dot2_f32_bf16 v246, v123, v234, v233
    v_dot2_f32_bf16 v247, v123, v235, v233
    v_cvt_pk_bf16_f32 v120, v240, v241
    v_dot2_f32_bf16 v240, v124, v234, v233
    v_dot2_f32_bf16 v241, v124, v235, v233
    v_cvt_pk_bf16_f32 v121, v242, v243
    v_dot2_f32_bf16 v242, v125, v234, v233
    v_dot2_f32_bf16 v243, v125, v235, v233
    v_cvt_pk_bf16_f32 v122, v244, v245
    v_dot2_f32_bf16 v244, v126, v234, v233
    v_dot2_f32_bf16 v245, v126, v235, v233
    v_cvt_pk_bf16_f32 v123, v246, v247
    v_dot2_f32_bf16 v246, v127, v234, v233
    v_dot2_f32_bf16 v247, v127, v235, v233
    v_cvt_pk_bf16_f32 v124, v240, v241
    v_cvt_pk_bf16_f32 v125, v242, v243
    v_cvt_pk_bf16_f32 v126, v244, v245
    v_cvt_pk_bf16_f32 v127, v246, v247
    v_mfma_f32_32x32x16_bf16 v[144:159], a[252:255], v[76:79], v[144:159]
    ds_read_b64_tr_b16 a[244:245], v209 offset:12544
    ds_read_b64_tr_b16 a[246:247], v209 offset:13056
    buffer_load_dwordx4 v197, s[44:47], s87 offen offset:1024  lds
    ds_read_b64_tr_b16 a[62:63], v210 offset:27904
    v_mfma_f32_32x32x16_bf16 v[128:143], a[224:227], v[80:83], v[128:143]
    s_waitcnt lgkmcnt(9)
    ds_read_b64_tr_b16 a[248:249], v209 offset:14336
    ds_read_b64_tr_b16 a[250:251], v209 offset:14848
    buffer_load_dwordx4 v198, s[44:47], s87 offen offset:2048  lds
    v_mfma_f32_32x32x16_bf16 v[144:159], a[228:231], v[80:83], v[144:159]
    ds_read_b64_tr_b16 a[252:253], v209 offset:14592
    ds_read_b64_tr_b16 a[254:255], v209 offset:15104
    buffer_load_dwordx4 v199, s[44:47], s87 offen offset:3072  lds
    s_mov_b32 s99, s3
    v_mfma_f32_32x32x16_bf16 v[128:143], a[232:235], v[84:87], v[128:143]
    s_waitcnt vmcnt(16) lgkmcnt(4)
    s_barrier
    ds_read_b64_tr_b16 a[224:225], v208 offset:0
    ds_read_b64_tr_b16 a[226:227], v208 offset:512
    v_mfma_f32_32x32x16_bf16 v[144:159], a[236:239], v[84:87], v[144:159]
    s_add_u32 m0, s73, 98304
    s_add_u32 s87, s92, 327680
    ds_read_b64_tr_b16 a[228:229], v208 offset:256
    ds_read_b64_tr_b16 a[230:231], v208 offset:768
    buffer_load_dwordx4 v200, s[48:51], s87 offen offset:0  lds
    v_mfma_f32_32x32x16_bf16 v[128:143], a[240:243], v[88:91], v[128:143]
    s_waitcnt lgkmcnt(6)
    ds_read_b64_tr_b16 a[232:233], v208 offset:2048
    ds_read_b64_tr_b16 a[234:235], v208 offset:2560
    ds_read_b64_tr_b16 a[64:65], v210 offset:32768
    ds_read_b64_tr_b16 a[66:67], v210 offset:33792
    ds_read_b64_tr_b16 a[68:69], v210 offset:33024
    v_mfma_f32_32x32x16_bf16 v[144:159], a[244:247], v[88:91], v[144:159]
    ds_read_b64_tr_b16 a[236:237], v208 offset:2304
    ds_read_b64_tr_b16 a[238:239], v208 offset:2816
    buffer_load_dwordx4 v201, s[48:51], s87 offen offset:1024  lds
    s_add_u32 s100, s3, 180224
    v_mfma_f32_32x32x16_bf16 v[128:143], a[248:251], v[92:95], v[128:143]
    s_waitcnt lgkmcnt(9)
    ds_read_b64_tr_b16 a[240:241], v208 offset:4096
    ds_read_b64_tr_b16 a[242:243], v208 offset:4608
    ds_read_b64_tr_b16 a[70:71], v210 offset:34048
    ds_read_b64_tr_b16 a[72:73], v210 offset:34816
    v_mfma_f32_32x32x16_bf16 v[144:159], a[252:255], v[92:95], v[144:159]
    ds_read_b64_tr_b16 a[244:245], v208 offset:4352
    ds_read_b64_tr_b16 a[246:247], v208 offset:4864
    buffer_load_dwordx4 v202, s[48:51], s87 offen offset:2048  lds
    v_mfma_f32_32x32x16_bf16 v[128:143], a[224:227], v[96:99], v[128:143]
    s_waitcnt lgkmcnt(11)
    ds_read_b64_tr_b16 a[248:249], v208 offset:6144
    ds_read_b64_tr_b16 a[250:251], v208 offset:6656
    ds_read_b64_tr_b16 a[74:75], v210 offset:35840
    ds_read_b64_tr_b16 a[76:77], v210 offset:35072
    ds_read_b64_tr_b16 a[78:79], v210 offset:36096
    v_mfma_f32_32x32x16_bf16 v[144:159], a[228:231], v[96:99], v[144:159]
    ds_read_b64_tr_b16 a[252:253], v208 offset:6400
    ds_read_b64_tr_b16 a[254:255], v208 offset:6912
    buffer_load_dwordx4 v203, s[48:51], s87 offen offset:3072  lds
    v_mfma_f32_32x32x16_bf16 v[128:143], a[232:235], v[100:103], v[128:143]
    s_waitcnt lgkmcnt(11)
    ds_read_b64_tr_b16 a[224:225], v208 offset:8192
    ds_read_b64_tr_b16 a[226:227], v208 offset:8704
    ds_read_b64_tr_b16 a[80:81], v210 offset:40960
    ds_read_b64_tr_b16 a[82:83], v210 offset:41984
    ds_read_b64_tr_b16 a[84:85], v210 offset:41216
    v_mfma_f32_32x32x16_bf16 v[144:159], a[236:239], v[100:103], v[144:159]
    s_add_u32 m0, s73, 49152
    s_add_u32 s87, s90, s85
    ds_read_b64_tr_b16 a[228:229], v208 offset:8448
    ds_read_b64_tr_b16 a[230:231], v208 offset:8960
    buffer_load_dwordx4 v196, s[44:47], s87 offen offset:0  lds
    v_mfma_f32_32x32x16_bf16 v[128:143], a[240:243], v[104:107], v[128:143]
    s_waitcnt lgkmcnt(12)
    ds_read_b64_tr_b16 a[232:233], v208 offset:10240
    ds_read_b64_tr_b16 a[234:235], v208 offset:10752
    ds_read_b64_tr_b16 a[86:87], v210 offset:42240
    ds_read_b64_tr_b16 a[88:89], v210 offset:43008
    v_mfma_f32_32x32x16_bf16 v[144:159], a[244:247], v[104:107], v[144:159]
    ds_read_b64_tr_b16 a[236:237], v208 offset:10496
    ds_read_b64_tr_b16 a[238:239], v208 offset:11008
    buffer_load_dwordx4 v197, s[44:47], s87 offen offset:1024  lds
    v_mfma_f32_32x32x16_bf16 v[128:143], a[248:251], v[108:111], v[128:143]
    s_waitcnt lgkmcnt(11)
    ds_read_b64_tr_b16 a[240:241], v208 offset:12288
    ds_read_b64_tr_b16 a[242:243], v208 offset:12800
    ds_read_b64_tr_b16 a[90:91], v210 offset:44032
    ds_read_b64_tr_b16 a[92:93], v210 offset:43264
    ds_read_b64_tr_b16 a[94:95], v210 offset:44288
    v_mfma_f32_32x32x16_bf16 v[144:159], a[252:255], v[108:111], v[144:159]
    ds_read_b64_tr_b16 a[244:245], v208 offset:12544
    ds_read_b64_tr_b16 a[246:247], v208 offset:13056
    buffer_load_dwordx4 v198, s[44:47], s87 offen offset:2048  lds
    v_mfma_f32_32x32x16_bf16 v[128:143], a[224:227], v[112:115], v[128:143]
    s_waitcnt lgkmcnt(11)
    ds_read_b64_tr_b16 a[248:249], v208 offset:14336
    ds_read_b64_tr_b16 a[250:251], v208 offset:14848
    v_mfma_f32_32x32x16_bf16 v[144:159], a[228:231], v[112:115], v[144:159]
    ds_read_b64_tr_b16 a[252:253], v208 offset:14592
    ds_read_b64_tr_b16 a[254:255], v208 offset:15104
    buffer_load_dwordx4 v199, s[44:47], s87 offen offset:3072  lds
    v_mfma_f32_32x32x16_bf16 v[128:143], a[232:235], v[116:119], v[128:143]
    s_waitcnt vmcnt(12) lgkmcnt(6)
    s_barrier
    ds_read_b64_tr_b16 a[224:225], v208 offset:16384
    ds_read_b64_tr_b16 a[226:227], v208 offset:16896
    v_mfma_f32_32x32x16_bf16 v[144:159], a[236:239], v[116:119], v[144:159]
    s_add_u32 m0, s73, 65536
    s_add_u32 s87, s90, s86
    ds_read_b64_tr_b16 a[228:229], v208 offset:16640
    ds_read_b64_tr_b16 a[230:231], v208 offset:17152
    buffer_load_dwordx4 v196, s[44:47], s87 offen offset:0  lds
    v_mfma_f32_32x32x16_bf16 v[128:143], a[240:243], v[120:123], v[128:143]
    s_waitcnt lgkmcnt(6)
    ds_read_b64_tr_b16 a[232:233], v208 offset:18432
    ds_read_b64_tr_b16 a[234:235], v208 offset:18944
    ds_read_b64_tr_b16 a[96:97], v210 offset:49152
    ds_read_b64_tr_b16 a[98:99], v210 offset:50176
    ds_read_b64_tr_b16 a[100:101], v210 offset:49408
    ds_read_b64_tr_b16 a[102:103], v210 offset:50432
    v_mfma_f32_32x32x16_bf16 v[144:159], a[244:247], v[120:123], v[144:159]
    ds_read_b64_tr_b16 a[236:237], v208 offset:18688
    ds_read_b64_tr_b16 a[238:239], v208 offset:19200
    buffer_load_dwordx4 v197, s[44:47], s87 offen offset:1024  lds
    ds_read_b64_tr_b16 a[104:105], v210 offset:51200
    ds_read_b64_tr_b16 a[106:107], v210 offset:52224
    v_mfma_f32_32x32x16_bf16 v[128:143], a[248:251], v[124:127], v[128:143]
    s_waitcnt lgkmcnt(12)
    s_nop 0
    ds_read_b64_tr_b16 a[240:241], v208 offset:20480
    ds_read_b64_tr_b16 a[242:243], v208 offset:20992
    ds_read_b64_tr_b16 a[108:109], v210 offset:51456
    ds_read_b64_tr_b16 a[110:111], v210 offset:52480
    ds_read_b64_tr_b16 a[112:113], v210 offset:57344
    ds_read_b64_tr_b16 a[114:115], v210 offset:58368
    v_mfma_f32_32x32x16_bf16 v[144:159], a[252:255], v[124:127], v[144:159]
    ds_read_b64_tr_b16 a[244:245], v208 offset:20736
    ds_read_b64_tr_b16 a[246:247], v208 offset:21248
    buffer_load_dwordx4 v198, s[44:47], s87 offen offset:2048  lds
    ds_read_b64_tr_b16 a[116:117], v210 offset:57600
    v_mfma_f32_32x32x16_bf16 v[160:175], a[224:227], v[0:3], v[160:175]
    s_waitcnt lgkmcnt(14)
    s_nop 0
    ds_read_b64_tr_b16 a[248:249], v208 offset:22528
    ds_read_b64_tr_b16 a[250:251], v208 offset:23040
    ds_read_b64_tr_b16 a[118:119], v210 offset:58624
    ds_read_b64_tr_b16 a[120:121], v210 offset:59392
    ds_read_b64_tr_b16 a[122:123], v210 offset:60416
    ds_read_b64_tr_b16 a[124:125], v210 offset:59648
    v_mfma_f32_32x32x16_bf16 v[176:191], a[228:231], v[0:3], v[176:191]
    ds_read_b64_tr_b16 a[252:253], v208 offset:22784
    ds_read_b64_tr_b16 a[254:255], v208 offset:23296
    buffer_load_dwordx4 v199, s[44:47], s87 offen offset:3072  lds
    ds_read_b64_tr_b16 a[126:127], v210 offset:60672
    v_mfma_f32_32x32x16_bf16 v[160:175], a[232:235], v[4:7], v[160:175]
    s_waitcnt lgkmcnt(14)
    ds_read_b64_tr_b16 a[224:225], v208 offset:24576
    ds_read_b64_tr_b16 a[226:227], v208 offset:25088
    v_exp_f32 v240, v128
    v_exp_f32 v241, v129
    v_add_f32 v240, 1.0, v240
    v_add_f32_e64 v241, 1.0, v241
    v_fma_f32 v240, v240, v240, 1.0 div:2
    v_mfma_f32_32x32x16_bf16 v[176:191], a[236:239], v[4:7], v[176:191]
    s_add_u32 m0, s73, 114688
    s_add_u32 s87, s92, 393216
    ds_read_b64_tr_b16 a[228:229], v208 offset:24832
    ds_read_b64_tr_b16 a[230:231], v208 offset:25344
    buffer_load_dwordx4 v200, s[48:51], s87 offen offset:0  lds
    v_fma_f32 v241, v241, v241, 1.0 div:2
    v_rcp_f32 v240, v240
    v_mfma_f32_32x32x16_bf16 v[160:175], a[240:243], v[8:11], v[160:175]
    s_waitcnt lgkmcnt(11)
    ds_read_b64_tr_b16 a[232:233], v208 offset:26624
    ds_read_b64_tr_b16 a[234:235], v208 offset:27136
    v_rcp_f32 v241, v241
    v_fma_f32 v240, -v128, v240, v128
    v_fma_f32 v241, -v129, v241, v129
    v_cvt_pk_bf16_f32 v128, v240, v241
    v_exp_f32 v240, v130
    v_mfma_f32_32x32x16_bf16 v[176:191], a[244:247], v[8:11], v[176:191]
    ds_read_b64_tr_b16 a[236:237], v208 offset:26880
    ds_read_b64_tr_b16 a[238:239], v208 offset:27392
    buffer_load_dwordx4 v201, s[48:51], s87 offen offset:1024  lds
    v_exp_f32 v241, v131
    v_add_f32 v240, 1.0, v240
    v_add_f32 v241, 1.0, v241
    v_mfma_f32_32x32x16_bf16 v[160:175], a[248:251], v[12:15], v[160:175]
    s_waitcnt lgkmcnt(6)
    ds_read_b64_tr_b16 a[240:241], v208 offset:28672
    ds_read_b64_tr_b16 a[242:243], v208 offset:29184
    v_fma_f32 v240, v240, v240, 1.0 div:2
    v_fma_f32 v241, v241, v241, 1.0 div:2
    v_rcp_f32 v240, v240
    v_rcp_f32 v241, v241
    v_fma_f32 v240, -v130, v240, v130
    v_mfma_f32_32x32x16_bf16 v[176:191], a[252:255], v[12:15], v[176:191]
    ds_read_b64_tr_b16 a[244:245], v208 offset:28928
    ds_read_b64_tr_b16 a[246:247], v208 offset:29440
    buffer_load_dwordx4 v202, s[48:51], s87 offen offset:2048  lds
    v_fma_f32 v241, -v131, v241, v131
    v_cvt_pk_bf16_f32 v129, v240, v241
    v_exp_f32 v240, v132
    v_mfma_f32_32x32x16_bf16 v[160:175], a[224:227], v[16:19], v[160:175]
    s_waitcnt lgkmcnt(6)
    ds_read_b64_tr_b16 a[248:249], v208 offset:30720
    ds_read_b64_tr_b16 a[250:251], v208 offset:31232
    v_exp_f32 v241, v133
    v_add_f32 v240, 1.0, v240
    v_add_f32 v241, 1.0, v241
    v_fma_f32 v240, v240, v240, 1.0 div:2
    v_fma_f32 v241, v241, v241, 1.0 div:2
    v_mfma_f32_32x32x16_bf16 v[176:191], a[228:231], v[16:19], v[176:191]
    ds_read_b64_tr_b16 a[252:253], v208 offset:30976
    ds_read_b64_tr_b16 a[254:255], v208 offset:31488
    buffer_load_dwordx4 v203, s[48:51], s87 offen offset:3072  lds
    v_rcp_f32 v240, v240
    v_rcp_f32 v241, v241
    v_fma_f32 v240, -v132, v240, v132
    v_mfma_f32_32x32x16_bf16 v[160:175], a[232:235], v[20:23], v[160:175]
    s_waitcnt vmcnt(16) lgkmcnt(6)
    s_barrier
    ds_read_b64_tr_b16 a[224:225], v208 offset:32768
    ds_read_b64_tr_b16 a[226:227], v208 offset:33280
    ds_read_b64_tr_b16 a[128:129], v210 offset:0
    ds_read_b64_tr_b16 a[130:131], v210 offset:1024
    v_fma_f32 v241, -v133, v241, v133
    v_mfma_f32_32x32x16_bf16 v[176:191], a[236:239], v[20:23], v[176:191]
    s_add_u32 m0, s73, 0
    s_add_u32 s87, s91, s79
    ds_read_b64_tr_b16 a[228:229], v208 offset:33024
    ds_read_b64_tr_b16 a[230:231], v208 offset:33536
    buffer_load_dwordx4 v192, s[40:43], s87 offen offset:0  lds
    ds_read_b64_tr_b16 a[132:133], v210 offset:256
    v_cvt_pk_bf16_f32 v130, v240, v241
    v_mfma_f32_32x32x16_bf16 v[160:175], a[240:243], v[24:27], v[160:175]
    s_waitcnt lgkmcnt(9)
    ds_read_b64_tr_b16 a[232:233], v208 offset:34816
    ds_read_b64_tr_b16 a[234:235], v208 offset:35328
    ds_read_b64_tr_b16 a[134:135], v210 offset:1280
    v_exp_f32 v240, v134
    v_exp_f32 v241, v135
    v_add_f32 v240, 1.0, v240
    v_add_f32 v241, 1.0, v241
    v_fma_f32 v240, v240, v240, 1.0 div:2
    v_mfma_f32_32x32x16_bf16 v[176:191], a[244:247], v[24:27], v[176:191]
    ds_read_b64_tr_b16 a[236:237], v208 offset:35072
    ds_read_b64_tr_b16 a[238:239], v208 offset:35584
    ds_read_b64_tr_b16 a[136:137], v210 offset:2048
    v_fma_f32 v241, v241, v241, 1.0 div:2
    v_rcp_f32 v240, v240
    v_rcp_f32 v241, v241
    v_fma_f32 v240, -v134, v240, v134
    v_mfma_f32_32x32x16_bf16 v[160:175], a[248:251], v[28:31], v[160:175]
    s_waitcnt lgkmcnt(11)
    s_nop 0
    ds_read_b64_tr_b16 a[240:241], v208 offset:36864
    ds_read_b64_tr_b16 a[242:243], v208 offset:37376
    ds_read_b64_tr_b16 a[138:139], v210 offset:3072
    ds_read_b64_tr_b16 a[140:141], v210 offset:2304
    v_fma_f32 v241, -v135, v241, v135
    v_cvt_pk_bf16_f32 v131, v240, v241
    v_mfma_f32_32x32x16_bf16 v[176:191], a[252:255], v[28:31], v[176:191]
    ds_read_b64_tr_b16 a[244:245], v208 offset:37120
    ds_read_b64_tr_b16 a[246:247], v208 offset:37632
    buffer_load_dwordx4 v193, s[40:43], s87 offen offset:1024  lds
    ds_read_b64_tr_b16 a[142:143], v210 offset:3328
    buffer_store_dwordx4 v[128:131], v211, s[60:63], s95 offen offset:0 sc1
    v_exp_f32 v240, v136
    v_mfma_f32_32x32x16_bf16 v[160:175], a[224:227], v[32:35], v[160:175]
    s_waitcnt lgkmcnt(11)
    ds_read_b64_tr_b16 a[248:249], v208 offset:38912
    ds_read_b64_tr_b16 a[250:251], v208 offset:39424
    ds_read_b64_tr_b16 a[144:145], v210 offset:8192
    v_exp_f32 v241, v137
    v_add_f32 v240, 1.0, v240
    v_add_f32 v241, 1.0, v241
    v_fma_f32 v240, v240, v240, 1.0 div:2
    v_fma_f32 v241, v241, v241, 1.0 div:2
    v_mfma_f32_32x32x16_bf16 v[176:191], a[228:231], v[32:35], v[176:191]
    ds_read_b64_tr_b16 a[252:253], v208 offset:39168
    ds_read_b64_tr_b16 a[254:255], v208 offset:39680
    ds_read_b64_tr_b16 a[146:147], v210 offset:9216
    v_rcp_f32 v240, v240
    v_rcp_f32 v241, v241
    v_fma_f32 v240, -v136, v240, v136
    v_fma_f32 v241, -v137, v241, v137
    v_mfma_f32_32x32x16_bf16 v[160:175], a[232:235], v[36:39], v[160:175]
    s_waitcnt lgkmcnt(11)
    ds_read_b64_tr_b16 a[224:225], v208 offset:40960
    ds_read_b64_tr_b16 a[226:227], v208 offset:41472
    ds_read_b64_tr_b16 a[148:149], v210 offset:8448
    ds_read_b64_tr_b16 a[150:151], v210 offset:9472
    v_cvt_pk_bf16_f32 v136, v240, v241
    v_exp_f32 v240, v138
    v_exp_f32 v241, v139
    v_mfma_f32_32x32x16_bf16 v[176:191], a[236:239], v[36:39], v[176:191]
    ds_read_b64_tr_b16 a[228:229], v208 offset:41216
    ds_read_b64_tr_b16 a[230:231], v208 offset:41728
    buffer_load_dwordx4 v194, s[40:43], s87 offen offset:2048  lds
    ds_read_b64_tr_b16 a[152:153], v210 offset:10240
    v_add_f32 v240, 1.0, v240
    v_add_f32 v241, 1.0, v241
    v_fma_f32 v240, v240, v240, 1.0 div:2
    v_mfma_f32_32x32x16_bf16 v[160:175], a[240:243], v[40:43], v[160:175]
    s_waitcnt lgkmcnt(11)
    ds_read_b64_tr_b16 a[232:233], v208 offset:43008
    ds_read_b64_tr_b16 a[234:235], v208 offset:43520
    ds_read_b64_tr_b16 a[154:155], v210 offset:11264
    v_fma_f32 v241, v241, v241, 1.0 div:2
    v_rcp_f32 v240, v240
    v_rcp_f32_e64 v241, v241
    v_fma_f32 v240, -v138, v240, v138
    v_mfma_f32_32x32x16_bf16 v[176:191], a[244:247], v[40:43], v[176:191]
    ds_read_b64_tr_b16 a[236:237], v208 offset:43264
    ds_read_b64_tr_b16 a[238:239], v208 offset:43776
    ds_read_b64_tr_b16 a[156:157], v210 offset:10496
    v_fma_f32 v241, -v139, v241, v139
    v_cvt_pk_bf16_f32 v137, v240, v241
    v_exp_f32 v240, v140
    v_exp_f32 v241, v141
    v_mfma_f32_32x32x16_bf16 v[160:175], a[248:251], v[44:47], v[160:175]
    s_waitcnt lgkmcnt(11)
    ds_read_b64_tr_b16 a[240:241], v208 offset:45056
    ds_read_b64_tr_b16 a[242:243], v208 offset:45568
    ds_read_b64_tr_b16 a[158:159], v210 offset:11520
    v_add_f32 v240, 1.0, v240
    v_add_f32 v241, 1.0, v241
    v_fma_f32 v240, v240, v240, 1.0 div:2
    v_fma_f32 v241, v241, v241, 1.0 div:2
    v_rcp_f32 v240, v240
    v_mfma_f32_32x32x16_bf16 v[176:191], a[252:255], v[44:47], v[176:191]
    ds_read_b64_tr_b16 a[244:245], v208 offset:45312
    ds_read_b64_tr_b16 a[246:247], v208 offset:45824
    buffer_load_dwordx4 v195, s[40:43], s87 offen offset:3072  lds
    v_rcp_f32 v241, v241
    v_fma_f32 v240, -v140, v240, v140
    v_fma_f32 v241, -v141, v241, v141
    v_mfma_f32_32x32x16_bf16 v[160:175], a[224:227], v[48:51], v[160:175]
    s_waitcnt lgkmcnt(9)
    ds_read_b64_tr_b16 a[248:249], v208 offset:47104
    ds_read_b64_tr_b16 a[250:251], v208 offset:47616
    v_cvt_pk_bf16_f32 v138, v240, v241
    v_exp_f32 v240, v142
    v_exp_f32 v241, v143
    v_add_f32 v240, 1.0, v240
    v_add_f32 v241, 1.0, v241
    v_mfma_f32_32x32x16_bf16 v[176:191], a[228:231], v[48:51], v[176:191]
    ds_read_b64_tr_b16 a[252:253], v208 offset:47360
    ds_read_b64_tr_b16 a[254:255], v208 offset:47872
    v_fma_f32 v240, v240, v240, 1.0 div:2
    v_fma_f32 v241, v241, v241, 1.0 div:2
    v_rcp_f32 v240, v240
    v_rcp_f32 v241, v241
    v_fma_f32 v240, -v142, v240, v142
    v_mfma_f32_32x32x16_bf16 v[160:175], a[232:235], v[52:55], v[160:175]
    s_waitcnt vmcnt(13) lgkmcnt(6)
    s_barrier
    ds_read_b64_tr_b16 a[224:225], v208 offset:49152
    ds_read_b64_tr_b16 a[226:227], v208 offset:49664
    ds_read_b64_tr_b16 a[160:161], v210 offset:16384
    ds_read_b64_tr_b16 a[162:163], v210 offset:17408
    v_fma_f32 v241, -v143, v241, v143
    v_mfma_f32_32x32x16_bf16 v[176:191], a[236:239], v[52:55], v[176:191]
    s_add_u32 m0, s73, 16384
    s_add_u32 s87, s91, s80
    ds_read_b64_tr_b16 a[228:229], v208 offset:49408
    ds_read_b64_tr_b16 a[230:231], v208 offset:49920
    buffer_load_dwordx4 v192, s[40:43], s87 offen offset:0  lds
    ds_read_b64_tr_b16 a[164:165], v210 offset:16640
    v_cvt_pk_bf16_f32 v139, v240, v241
    v_mfma_f32_32x32x16_bf16 v[160:175], a[240:243], v[56:59], v[160:175]
    s_waitcnt lgkmcnt(9)
    ds_read_b64_tr_b16 a[232:233], v208 offset:51200
    ds_read_b64_tr_b16 a[234:235], v208 offset:51712
    ds_read_b64_tr_b16 a[166:167], v210 offset:17664
    buffer_store_dwordx4 v[136:139], v211, s[60:63], s95 offen offset:1024 sc1
    v_exp_f32_e64 v240, v144
    v_mfma_f32_32x32x16_bf16 v[176:191], a[244:247], v[56:59], v[176:191]
    ds_read_b64_tr_b16 a[236:237], v208 offset:51456
    ds_read_b64_tr_b16 a[238:239], v208 offset:51968
    buffer_load_dwordx4 v193, s[40:43], s87 offen offset:1024  lds
    ds_read_b64_tr_b16 a[168:169], v210 offset:18432
    v_exp_f32 v241, v145
    v_add_f32 v240, 1.0, v240
    v_add_f32 v241, 1.0, v241
    v_mfma_f32_32x32x16_bf16 v[160:175], a[248:251], v[60:63], v[160:175]
    s_waitcnt lgkmcnt(11)
    ds_read_b64_tr_b16 a[240:241], v208 offset:53248
    ds_read_b64_tr_b16 a[242:243], v208 offset:53760
    ds_read_b64_tr_b16 a[170:171], v210 offset:19456
    ds_read_b64_tr_b16 a[172:173], v210 offset:18688
    v_fma_f32 v240, v240, v240, 1.0 div:2
    v_fma_f32 v241, v241, v241, 1.0 div:2
    v_rcp_f32_e64 v240, v240
    v_mfma_f32_32x32x16_bf16 v[176:191], a[252:255], v[60:63], v[176:191]
    ds_read_b64_tr_b16 a[244:245], v208 offset:53504
    ds_read_b64_tr_b16 a[246:247], v208 offset:54016
    buffer_load_dwordx4 v194, s[40:43], s87 offen offset:2048  lds
    ds_read_b64_tr_b16 a[174:175], v210 offset:19712
    v_rcp_f32 v241, v241
    v_fma_f32 v240, -v144, v240, v144
    v_mfma_f32_32x32x16_bf16 v[160:175], a[224:227], v[64:67], v[160:175]
    s_waitcnt lgkmcnt(11)
    ds_read_b64_tr_b16 a[248:249], v208 offset:55296
    ds_read_b64_tr_b16 a[250:251], v208 offset:55808
    ds_read_b64_tr_b16 a[176:177], v210 offset:24576
    v_fma_f32 v241, -v145, v241, v145
    v_cvt_pk_bf16_f32 v144, v240, v241
    v_exp_f32 v240, v146
    v_exp_f32 v241, v147
    v_mfma_f32_32x32x16_bf16 v[176:191], a[228:231], v[64:67], v[176:191]
    ds_read_b64_tr_b16 a[252:253], v208 offset:55552
    ds_read_b64_tr_b16 a[254:255], v208 offset:56064
    buffer_load_dwordx4 v195, s[40:43], s87 offen offset:3072  lds
    ds_read_b64_tr_b16 a[178:179], v210 offset:25600
    v_add_f32 v240, 1.0, v240
    v_add_f32 v241, 1.0, v241
    v_fma_f32 v240, v240, v240, 1.0 div:2
    v_mfma_f32_32x32x16_bf16 v[160:175], a[232:235], v[68:71], v[160:175]
    s_waitcnt lgkmcnt(11)
    ds_read_b64_tr_b16 a[224:225], v208 offset:57344
    ds_read_b64_tr_b16 a[226:227], v208 offset:57856
    ds_read_b64_tr_b16 a[180:181], v210 offset:24832
    ds_read_b64_tr_b16 a[182:183], v210 offset:25856
    v_fma_f32 v241, v241, v241, 1.0 div:2
    v_rcp_f32 v240, v240
    v_rcp_f32 v241, v241
    v_mfma_f32_32x32x16_bf16 v[176:191], a[236:239], v[68:71], v[176:191]
    s_add_u32 m0, s73, 131072
    s_add_u32 s87, s93, 0
    ds_read_b64_tr_b16 a[228:229], v208 offset:57600
    ds_read_b64_tr_b16 a[230:231], v208 offset:58112
    buffer_load_dwordx4 v192, s[52:55], s87 offen offset:0  lds
    ds_read_b64_tr_b16 a[184:185], v210 offset:26624
    v_fma_f32 v240, -v146, v240, v146
    v_fma_f32 v241, -v147, v241, v147
    v_mfma_f32_32x32x16_bf16 v[160:175], a[240:243], v[72:75], v[160:175]
    s_waitcnt lgkmcnt(11)
    ds_read_b64_tr_b16 a[232:233], v208 offset:59392
    ds_read_b64_tr_b16 a[234:235], v208 offset:59904
    ds_read_b64_tr_b16 a[186:187], v210 offset:27648
    v_cvt_pk_bf16_f32 v145, v240, v241
    v_exp_f32 v240, v148
    v_exp_f32 v241, v149
    v_add_f32 v240, 1.0, v240
    v_mfma_f32_32x32x16_bf16 v[176:191], a[244:247], v[72:75], v[176:191]
    ds_read_b64_tr_b16 a[236:237], v208 offset:59648
    ds_read_b64_tr_b16 a[238:239], v208 offset:60160
    buffer_load_dwordx4 v193, s[52:55], s87 offen offset:1024  lds
    ds_read_b64_tr_b16 a[188:189], v210 offset:26880
    v_add_f32 v241, 1.0, v241
    v_fma_f32 v240, v240, v240, 1.0 div:2
    v_fma_f32 v241, v241, v241, 1.0 div:2
    v_mfma_f32_32x32x16_bf16 v[160:175], a[248:251], v[76:79], v[160:175]
    s_waitcnt lgkmcnt(11)
    ds_read_b64_tr_b16 a[240:241], v208 offset:61440
    ds_read_b64_tr_b16 a[242:243], v208 offset:61952
    ds_read_b64_tr_b16 a[190:191], v210 offset:27904
    v_rcp_f32 v240, v240
    v_rcp_f32 v241, v241
    v_fma_f32 v240, -v148, v240, v148
    v_fma_f32 v241, -v149, v241, v149
    v_mfma_f32_32x32x16_bf16 v[176:191], a[252:255], v[76:79], v[176:191]
    ds_read_b64_tr_b16 a[244:245], v208 offset:61696
    ds_read_b64_tr_b16 a[246:247], v208 offset:62208
    buffer_load_dwordx4 v194, s[52:55], s87 offen offset:2048  lds
    v_cvt_pk_bf16_f32 v146, v240, v241
    v_exp_f32 v240, v150
    v_exp_f32 v241, v151
    v_mfma_f32_32x32x16_bf16 v[160:175], a[224:227], v[80:83], v[160:175]
    s_waitcnt lgkmcnt(9)
    ds_read_b64_tr_b16 a[248:249], v208 offset:63488
    ds_read_b64_tr_b16 a[250:251], v208 offset:64000
    v_add_f32 v240, 1.0, v240
    v_add_f32 v241, 1.0, v241
    v_fma_f32 v240, v240, v240, 1.0 div:2
    v_fma_f32 v241, v241, v241, 1.0 div:2
    v_rcp_f32 v240, v240
    v_mfma_f32_32x32x16_bf16 v[176:191], a[228:231], v[80:83], v[176:191]
    ds_read_b64_tr_b16 a[252:253], v208 offset:63744
    ds_read_b64_tr_b16 a[254:255], v208 offset:64256
    buffer_load_dwordx4 v195, s[52:55], s87 offen offset:3072  lds
    v_rcp_f32 v241, v241
    v_fma_f32 v240, -v150, v240, v150
    v_fma_f32 v241, -v151, v241, v151
    v_mfma_f32_32x32x16_bf16 v[160:175], a[232:235], v[84:87], v[160:175]
    s_waitcnt vmcnt(14) lgkmcnt(6)
    s_barrier
    ds_read_b64_tr_b16 a[224:225], v209 offset:0
    ds_read_b64_tr_b16 a[226:227], v209 offset:512
    ds_read_b64_tr_b16 a[192:193], v210 offset:32768
    ds_read_b64_tr_b16 a[194:195], v210 offset:33792
    v_cvt_pk_bf16_f32 v147, v240, v241
    v_mfma_f32_32x32x16_bf16 v[176:191], a[236:239], v[84:87], v[176:191]
    s_add_u32 m0, s73, 32768
    s_add_u32 s87, s91, s81
    ds_read_b64_tr_b16 a[228:229], v209 offset:256
    ds_read_b64_tr_b16 a[230:231], v209 offset:768
    buffer_load_dwordx4 v192, s[40:43], s87 offen offset:0  lds
    ds_read_b64_tr_b16 a[196:197], v210 offset:33024
    buffer_store_dwordx4 v[144:147], v211, s[60:63], s95 offen offset:2048 sc1
    v_mfma_f32_32x32x16_bf16 v[160:175], a[240:243], v[88:91], v[160:175]
    s_waitcnt lgkmcnt(9)
    ds_read_b64_tr_b16 a[232:233], v209 offset:2048
    ds_read_b64_tr_b16 a[234:235], v209 offset:2560
    ds_read_b64_tr_b16 a[198:199], v210 offset:34048
    v_exp_f32 v240, v152
    v_exp_f32_e64 v241, v153
    v_mfma_f32_32x32x16_bf16 v[176:191], a[244:247], v[88:91], v[176:191]
    ds_read_b64_tr_b16 a[236:237], v209 offset:2304
    ds_read_b64_tr_b16 a[238:239], v209 offset:2816
    buffer_load_dwordx4 v193, s[40:43], s87 offen offset:1024  lds
    ds_read_b64_tr_b16 a[200:201], v210 offset:34816
    v_add_f32 v240, 1.0, v240
    v_add_f32 v241, 1.0, v241
    v_fma_f32 v240, v240, v240, 1.0 div:2
    v_mfma_f32_32x32x16_bf16 v[160:175], a[248:251], v[92:95], v[160:175]
    s_waitcnt vmcnt(10) lgkmcnt(11)
    ds_read_b64_tr_b16 a[240:241], v209 offset:4096
    ds_read_b64_tr_b16 a[242:243], v209 offset:4608
    ds_read_b64_tr_b16 a[202:203], v210 offset:35840
    ds_read_b64_tr_b16 a[204:205], v210 offset:35072
    s_mov_b64 exec, 1
    buffer_store_dword v252, off, s[60:63], s98 sc1
    s_mov_b64 exec, -1
    s_add_u32 s98, s98, 1024
    v_mfma_f32_32x32x16_bf16 v[176:191], a[252:255], v[92:95], v[176:191]
    ds_read_b64_tr_b16 a[244:245], v209 offset:4352
    ds_read_b64_tr_b16 a[246:247], v209 offset:4864
    buffer_load_dwordx4 v194, s[40:43], s87 offen offset:2048  lds
    ds_read_b64_tr_b16 a[206:207], v210 offset:36096
    v_fma_f32 v241, v241, v241, 1.0 div:2
    v_rcp_f32 v240, v240
    v_mfma_f32_32x32x16_bf16 v[160:175], a[224:227], v[96:99], v[160:175]
    s_waitcnt lgkmcnt(11)
    ds_read_b64_tr_b16 a[248:249], v209 offset:6144
    ds_read_b64_tr_b16 a[250:251], v209 offset:6656
    ds_read_b64_tr_b16 a[208:209], v210 offset:40960
    v_rcp_f32 v241, v241
    v_fma_f32 v240, -v152, v240, v152
    v_fma_f32 v241, -v153, v241, v153
    v_cvt_pk_bf16_f32 v152, v240, v241
    v_exp_f32_e64 v240, v154
    v_mfma_f32_32x32x16_bf16 v[176:191], a[228:231], v[96:99], v[176:191]
    ds_read_b64_tr_b16 a[252:253], v209 offset:6400
    ds_read_b64_tr_b16 a[254:255], v209 offset:6912
    buffer_load_dwordx4 v195, s[40:43], s87 offen offset:3072  lds
    ds_read_b64_tr_b16 a[210:211], v210 offset:41984
    v_exp_f32 v241, v155
    v_mfma_f32_32x32x16_bf16 v[160:175], a[232:235], v[100:103], v[160:175]
    s_waitcnt lgkmcnt(11)
    ds_read_b64_tr_b16 a[224:225], v209 offset:8192
    ds_read_b64_tr_b16 a[226:227], v209 offset:8704
    ds_read_b64_tr_b16 a[212:213], v210 offset:41216
    ds_read_b64_tr_b16 a[214:215], v210 offset:42240
    v_add_f32 v240, 1.0, v240
    v_add_f32 v241, 1.0, v241
    v_fma_f32 v240, v240, v240, 1.0 div:2
    v_fma_f32 v241, v241, v241, 1.0 div:2
    v_rcp_f32 v240, v240
    v_mfma_f32_32x32x16_bf16 v[176:191], a[236:239], v[100:103], v[176:191]
    s_add_u32 m0, s73, 81920
    s_add_u32 s87, s94, 0
    ds_read_b64_tr_b16 a[228:229], v209 offset:8448
    ds_read_b64_tr_b16 a[230:231], v209 offset:8960
    buffer_load_dwordx4 v192, s[52:55], s87 offen offset:0  lds
    ds_read_b64_tr_b16 a[216:217], v210 offset:43008
    v_rcp_f32 v241, v241
    v_mfma_f32_32x32x16_bf16 v[160:175], a[240:243], v[104:107], v[160:175]
    s_waitcnt lgkmcnt(11)
    ds_read_b64_tr_b16 a[232:233], v209 offset:10240
    ds_read_b64_tr_b16 a[234:235], v209 offset:10752
    ds_read_b64_tr_b16 a[218:219], v210 offset:44032
    v_fma_f32 v240, -v154, v240, v154
    v_fma_f32 v241, -v155, v241, v155
    v_cvt_pk_bf16_f32 v153, v240, v241
    v_exp_f32_e64 v240, v156
    v_mfma_f32_32x32x16_bf16 v[176:191], a[244:247], v[104:107], v[176:191]
    ds_read_b64_tr_b16 a[236:237], v209 offset:10496
    ds_read_b64_tr_b16 a[238:239], v209 offset:11008
    buffer_load_dwordx4 v193, s[52:55], s87 offen offset:1024  lds
    ds_read_b64_tr_b16 a[220:221], v210 offset:43264
    v_exp_f32 v241, v157
    v_add_f32 v240, 1.0, v240
    v_mfma_f32_32x32x16_bf16 v[160:175], a[248:251], v[108:111], v[160:175]
    s_waitcnt lgkmcnt(11)
    ds_read_b64_tr_b16 a[240:241], v209 offset:12288
    ds_read_b64_tr_b16 a[242:243], v209 offset:12800
    ds_read_b64_tr_b16 a[222:223], v210 offset:44288
    v_add_f32 v241, 1.0, v241
    v_fma_f32 v240, v240, v240, 1.0 div:2
    v_fma_f32 v241, v241, v241, 1.0 div:2
    v_rcp_f32 v240, v240
    v_rcp_f32 v241, v241
    v_mfma_f32_32x32x16_bf16 v[176:191], a[252:255], v[108:111], v[176:191]
    ds_read_b64_tr_b16 a[244:245], v209 offset:12544
    ds_read_b64_tr_b16 a[246:247], v209 offset:13056
    buffer_load_dwordx4 v194, s[52:55], s87 offen offset:2048  lds
    v_fma_f32 v240, -v156, v240, v156
    v_fma_f32 v241, -v157, v241, v157
    v_cvt_pk_bf16_f32 v154, v240, v241
    v_mfma_f32_32x32x16_bf16 v[160:175], a[224:227], v[112:115], v[160:175]
    s_waitcnt lgkmcnt(9)
    ds_read_b64_tr_b16 a[248:249], v209 offset:14336
    ds_read_b64_tr_b16 a[250:251], v209 offset:14848
    v_exp_f32 v240, v158
    v_exp_f32 v241, v159
    v_add_f32 v240, 1.0, v240
    v_add_f32_e64 v241, 1.0, v241
    v_fma_f32 v240, v240, v240, 1.0 div:2
    v_mfma_f32_32x32x16_bf16 v[176:191], a[228:231], v[112:115], v[176:191]
    ds_read_b64_tr_b16 a[252:253], v209 offset:14592
    ds_read_b64_tr_b16 a[254:255], v209 offset:15104
    buffer_load_dwordx4 v195, s[52:55], s87 offen offset:3072  lds
    v_fma_f32 v241, v241, v241, 1.0 div:2
    v_rcp_f32 v240, v240
    v_rcp_f32 v241, v241
    v_mfma_f32_32x32x16_bf16 v[160:175], a[232:235], v[116:119], v[160:175]
    s_waitcnt lgkmcnt(6)
    s_barrier
    ds_read_b128 a[224:227], v204 offset:0
    v_fma_f32 v240, -v158, v240, v158
    v_fma_f32 v241, -v159, v241, v159
    v_cvt_pk_bf16_f32 v155, v240, v241
    v_mfma_f32_32x32x16_bf16 v[176:191], a[236:239], v[116:119], v[176:191]
    s_add_u32 m0, s73, 49152
    s_add_u32 s87, s91, s82
    ds_read_b128 a[228:231], v204 offset:8192
    buffer_load_dwordx4 v192, s[40:43], s87 offen offset:0  lds
    buffer_store_dwordx4 v[152:155], v211, s[60:63], s95 offen offset:3072 sc1
    v_mfma_f32_32x32x16_bf16 v[160:175], a[240:243], v[120:123], v[160:175]
    s_waitcnt lgkmcnt(4)
    ds_read_b128 a[232:235], v205 offset:0
    v_mfma_f32_32x32x16_bf16 v[176:191], a[244:247], v[120:123], v[176:191]
    ds_read_b128 a[236:239], v205 offset:8192
    buffer_load_dwordx4 v193, s[40:43], s87 offen offset:1024  lds
    v_mfma_f32_32x32x16_bf16 v[160:175], a[248:251], v[124:127], v[160:175]
    s_waitcnt lgkmcnt(3)
    ds_read_b128 a[240:243], v206 offset:0
    v_mfma_f32_32x32x16_bf16 v[176:191], a[252:255], v[124:127], v[176:191]
    ds_read_b128 a[244:247], v206 offset:8192
    buffer_load_dwordx4 v194, s[40:43], s87 offen offset:2048  lds
    v_mfma_f32_32x32x16_bf16 v[128:143], v[0:3], a[224:227], 0
    s_waitcnt lgkmcnt(3)
    ds_read_b128 a[248:251], v207 offset:0
    v_and_b32 v210, 0x200, v211
    v_lshl_add_u32 v210, v210, 8, v211
    v_mfma_f32_32x32x16_bf16 v[144:159], v[0:3], a[228:231], 0
    ds_read_b128 a[252:255], v207 offset:8192
    buffer_load_dwordx4 v195, s[40:43], s87 offen offset:3072  lds
    v_exp_f32 v240, v160
    v_exp_f32 v241, v161
    v_mfma_f32_32x32x16_bf16 v[128:143], v[4:7], a[232:235], v[128:143]
    s_waitcnt lgkmcnt(3)
    ds_read_b128 a[224:227], v204 offset:4096
    v_add_f32 v240, 1.0, v240
    v_add_f32 v241, 1.0, v241
    v_fma_f32 v240, v240, v240, 1.0 div:2
    v_fma_f32 v241, v241, v241, 1.0 div:2
    v_rcp_f32 v240, v240
    v_mfma_f32_32x32x16_bf16 v[144:159], v[4:7], a[236:239], v[144:159]
    s_add_u32 m0, s73, 98304
    s_add_u32 s87, s93, 128
    ds_read_b128 a[228:231], v204 offset:12288
    buffer_load_dwordx4 v192, s[52:55], s87 offen offset:0  lds
    v_rcp_f32 v241, v241
    v_fma_f32 v240, -v160, v240, v160
    v_mfma_f32_32x32x16_bf16 v[128:143], v[8:11], a[240:243], v[128:143]
    s_waitcnt lgkmcnt(3)
    ds_read_b128 a[232:235], v205 offset:4096
    v_fma_f32 v241, -v161, v241, v161
    v_cvt_pk_bf16_f32 v160, v240, v241
    v_exp_f32 v240, v162
    v_exp_f32 v241, v163
    v_add_f32 v240, 1.0, v240
    v_mfma_f32_32x32x16_bf16 v[144:159], v[8:11], a[244:247], v[144:159]
    ds_read_b128 a[236:239], v205 offset:12288
    buffer_load_dwordx4 v193, s[52:55], s87 offen offset:1024  lds
    v_add_f32 v241, 1.0, v241
    v_fma_f32 v240, v240, v240, 1.0 div:2
    v_fma_f32 v241, v241, v241, 1.0 div:2
    v_mfma_f32_32x32x16_bf16 v[128:143], v[12:15], a[248:251], v[128:143]
    s_waitcnt lgkmcnt(3)
    ds_read_b128 a[240:243], v206 offset:4096
    v_rcp_f32 v240, v240
    v_rcp_f32 v241, v241
    v_fma_f32 v240, -v162, v240, v162
    v_fma_f32 v241, -v163, v241, v163
    v_cvt_pk_bf16_f32 v161, v240, v241
    v_mfma_f32_32x32x16_bf16 v[144:159], v[12:15], a[252:255], v[144:159]
    ds_read_b128 a[244:247], v206 offset:12288
    buffer_load_dwordx4 v194, s[52:55], s87 offen offset:2048  lds
    v_exp_f32 v240, v164
    v_exp_f32 v241, v165
    v_mfma_f32_32x32x16_bf16 v[128:143], v[16:19], a[224:227], v[128:143]
    s_waitcnt lgkmcnt(3)
    ds_read_b128 a[248:251], v207 offset:4096
    v_add_f32 v240, 1.0, v240
    v_add_f32 v241, 1.0, v241
    v_fma_f32 v240, v240, v240, 1.0 div:2
    v_fma_f32 v241, v241, v241, 1.0 div:2
    v_rcp_f32 v240, v240
    v_rcp_f32 v241, v241
    v_mfma_f32_32x32x16_bf16 v[144:159], v[16:19], a[228:231], v[144:159]
    ds_read_b128 a[252:255], v207 offset:12288
    buffer_load_dwordx4 v195, s[52:55], s87 offen offset:3072  lds
    v_fma_f32 v240, -v164, v240, v164
    v_fma_f32 v241, -v165, v241, v165
    v_cvt_pk_bf16_f32 v162, v240, v241
    v_mfma_f32_32x32x16_bf16 v[128:143], v[20:23], a[232:235], v[128:143]
    s_waitcnt vmcnt(23) lgkmcnt(3)
    s_barrier
    ds_read_b128 a[224:227], v204 offset:16384
    buffer_load_dword v255, v253, s[60:63], s77 offen offset:0 sc1
    v_mfma_f32_32x32x16_bf16 v[144:159], v[20:23], a[236:239], v[144:159]
    s_add_u32 m0, s73, 114688
    s_add_u32 s87, s94, 128
    ds_read_b128 a[228:231], v204 offset:24576
    buffer_load_dwordx4 v192, s[52:55], s87 offen offset:0  lds
    v_exp_f32 v240, v166
    v_mfma_f32_32x32x16_bf16 v[128:143], v[24:27], a[240:243], v[128:143]
    s_waitcnt lgkmcnt(3)
    ds_read_b128 a[232:235], v205 offset:16384
    v_exp_f32 v241, v167
    v_add_f32 v240, 1.0, v240
    v_add_f32 v241, 1.0, v241
    v_fma_f32 v240, v240, v240, 1.0 div:2
    v_fma_f32 v241, v241, v241, 1.0 div:2
    v_rcp_f32 v240, v240
    v_mfma_f32_32x32x16_bf16 v[144:159], v[24:27], a[244:247], v[144:159]
    ds_read_b128 a[236:239], v205 offset:24576
    v_rcp_f32 v241, v241
    v_fma_f32 v240, -v166, v240, v166
    v_fma_f32 v241, -v167, v241, v167
    v_cvt_pk_bf16_f32 v163, v240, v241
    v_mfma_f32_32x32x16_bf16 v[128:143], v[28:31], a[248:251], v[128:143]
    s_waitcnt lgkmcnt(3)
    ds_read_b128 a[240:243], v206 offset:16384
    buffer_store_dwordx4 v[160:163], v211, s[60:63], s96 offen offset:0 sc1
    v_exp_f32 v240, v168
    v_exp_f32 v241, v169
    v_mfma_f32_32x32x16_bf16 v[144:159], v[28:31], a[252:255], v[144:159]
    ds_read_b128 a[244:247], v206 offset:24576
    buffer_load_dwordx4 v193, s[52:55], s87 offen offset:1024  lds
    v_add_f32 v240, 1.0, v240
    v_add_f32 v241, 1.0, v241
    v_fma_f32 v240, v240, v240, 1.0 div:2
    v_fma_f32 v241, v241, v241, 1.0 div:2
    v_mfma_f32_32x32x16_bf16 v[128:143], v[32:35], a[224:227], v[128:143]
    s_waitcnt vmcnt(11) lgkmcnt(3)
    ds_read_b128 a[248:251], v207 offset:16384
    s_mov_b64 exec, 1
    buffer_store_dword v252, off, s[60:63], s98 sc1
    s_mov_b64 exec, -1
    s_add_u32 s98, s98, 1024
    v_mfma_f32_32x32x16_bf16 v[144:159], v[32:35], a[228:231], v[144:159]
    ds_read_b128 a[252:255], v207 offset:24576
    v_rcp_f32 v240, v240
    v_rcp_f32 v241, v241
    v_fma_f32 v240, -v168, v240, v168
    v_fma_f32 v241, -v169, v241, v169
    v_cvt_pk_bf16_f32 v168, v240, v241
    v_mfma_f32_32x32x16_bf16 v[128:143], v[36:39], a[232:235], v[128:143]
    s_waitcnt lgkmcnt(3)
    ds_read_b128 a[224:227], v204 offset:20480
    v_exp_f32 v240, v170
    v_exp_f32 v241, v171
    v_add_f32 v240, 1.0, v240
    v_add_f32 v241, 1.0, v241
    v_mfma_f32_32x32x16_bf16 v[144:159], v[36:39], a[236:239], v[144:159]
    ds_read_b128 a[228:231], v204 offset:28672
    buffer_load_dwordx4 v194, s[52:55], s87 offen offset:2048  lds
    v_fma_f32 v240, v240, v240, 1.0 div:2
    v_fma_f32 v241, v241, v241, 1.0 div:2
    v_rcp_f32 v240, v240
    v_mfma_f32_32x32x16_bf16 v[128:143], v[40:43], a[240:243], v[128:143]
    s_waitcnt lgkmcnt(3)
    ds_read_b128 a[232:235], v205 offset:20480
    v_rcp_f32 v241, v241
    v_fma_f32 v240, -v170, v240, v170
    v_fma_f32 v241, -v171, v241, v171
    v_cvt_pk_bf16_f32 v169, v240, v241
    v_exp_f32 v240, v172
    v_mfma_f32_32x32x16_bf16 v[144:159], v[40:43], a[244:247], v[144:159]
    ds_read_b128 a[236:239], v205 offset:28672
    v_exp_f32 v241, v173
    v_add_f32 v240, 1.0, v240
    v_add_f32 v241, 1.0, v241
    v_fma_f32 v240, v240, v240, 1.0 div:2
    v_fma_f32 v241, v241, v241, 1.0 div:2
    v_mfma_f32_32x32x16_bf16 v[128:143], v[44:47], a[248:251], v[128:143]
    s_waitcnt lgkmcnt(3)
    ds_read_b128 a[240:243], v206 offset:20480
    v_rcp_f32 v240, v240
    v_rcp_f32 v241, v241
    v_fma_f32 v240, -v172, v240, v172
    v_fma_f32 v241, -v173, v241, v173
    v_cvt_pk_bf16_f32 v170, v240, v241
    v_mfma_f32_32x32x16_bf16 v[144:159], v[44:47], a[252:255], v[144:159]
    ds_read_b128 a[244:247], v206 offset:28672
    buffer_load_dwordx4 v195, s[52:55], s87 offen offset:3072  lds
    v_exp_f32 v240, v174
    v_exp_f32 v241, v175
    v_mfma_f32_32x32x16_bf16 v[128:143], v[48:51], a[224:227], v[128:143]
    s_waitcnt lgkmcnt(3)
    ds_read_b128 a[248:251], v207 offset:20480
    v_add_f32 v240, 1.0, v240
    v_add_f32 v241, 1.0, v241
    v_fma_f32 v240, v240, v240, 1.0 div:2
    v_fma_f32 v241, v241, v241, 1.0 div:2
    v_rcp_f32 v240, v240
    v_mfma_f32_32x32x16_bf16 v[144:159], v[48:51], a[228:231], v[144:159]
    ds_read_b128 a[252:255], v207 offset:28672
    v_rcp_f32 v241, v241
    v_fma_f32 v240, -v174, v240, v174
    v_fma_f32 v241, -v175, v241, v175
    v_cvt_pk_bf16_f32 v171, v240, v241
    v_mfma_f32_32x32x16_bf16 v[128:143], v[52:55], a[232:235], v[128:143]
    s_waitcnt lgkmcnt(3)
    s_barrier
    ds_read_b128 a[224:227], v204 offset:32768
    buffer_store_dwordx4 v[168:171], v211, s[60:63], s96 offen offset:1024 sc1
    v_exp_f32 v240, v176
    v_mfma_f32_32x32x16_bf16 v[144:159], v[52:55], a[236:239], v[144:159]
    ds_read_b128 a[228:231], v204 offset:40960
    v_exp_f32 v241, v177
    v_add_f32 v240, 1.0, v240
    v_add_f32 v241, 1.0, v241
    v_fma_f32 v240, v240, v240, 1.0 div:2
    v_fma_f32 v241, v241, v241, 1.0 div:2
    v_mfma_f32_32x32x16_bf16 v[128:143], v[56:59], a[240:243], v[128:143]
    s_waitcnt lgkmcnt(3)
    ds_read_b128 a[232:235], v205 offset:32768
    v_rcp_f32 v240, v240
    v_rcp_f32 v241, v241
    v_fma_f32 v240, -v176, v240, v176
    v_fma_f32 v241, -v177, v241, v177
    v_cvt_pk_bf16_f32 v176, v240, v241
    v_mfma_f32_32x32x16_bf16 v[144:159], v[56:59], a[244:247], v[144:159]
    s_waitcnt vmcnt(7)
    ds_read_b128 a[236:239], v205 offset:40960
    v_exp_f32 v240, v178
    v_exp_f32 v241, v179
    v_add_f32 v240, 1.0, v240
    v_cmp_ne_u32 vcc, s74, v255
    s_nop 0
    s_cbranch_vccnz L_sp0
L_pr0:
    v_mfma_f32_32x32x16_bf16 v[128:143], v[60:63], a[248:251], v[128:143]
    s_waitcnt lgkmcnt(3)
    ds_read_b128 a[240:243], v206 offset:32768
    buffer_load_dwordx4 v[0:3], v211, s[60:63], s99 offen offset:0 sc1
    v_add_f32 v241, 1.0, v241
    v_fma_f32 v240, v240, v240, 1.0 div:2
    v_fma_f32 v241, v241, v241, 1.0 div:2
    v_mfma_f32_32x32x16_bf16 v[144:159], v[60:63], a[252:255], v[144:159]
    ds_read_b128 a[244:247], v206 offset:40960
    v_rcp_f32 v240, v240
    v_rcp_f32 v241, v241
    v_fma_f32 v240, -v178, v240, v178
    v_fma_f32 v241, -v179, v241, v179
    v_cvt_pk_bf16_f32 v177, v240, v241
    v_mfma_f32_32x32x16_bf16 v[128:143], v[64:67], a[224:227], v[128:143]
    s_waitcnt lgkmcnt(3)
    ds_read_b128 a[248:251], v207 offset:32768
    buffer_load_dwordx4 v[4:7], v211, s[60:63], s100 offen offset:0 sc1
    v_exp_f32 v240, v180
    v_exp_f32 v241, v181
    v_mfma_f32_32x32x16_bf16 v[144:159], v[64:67], a[228:231], v[144:159]
    ds_read_b128 a[252:255], v207 offset:40960
    v_add_f32 v240, 1.0, v240
    v_add_f32 v241, 1.0, v241
    v_fma_f32 v240, v240, v240, 1.0 div:2
    v_fma_f32 v241, v241, v241, 1.0 div:2
    v_rcp_f32 v240, v240
    v_mfma_f32_32x32x16_bf16 v[128:143], v[68:71], a[232:235], v[128:143]
    s_waitcnt lgkmcnt(3)
    ds_read_b128 a[224:227], v204 offset:36864
    buffer_load_dwordx4 v[8:11], v211, s[60:63], s99 offen offset:1024 sc1
    v_rcp_f32 v241, v241
    v_fma_f32 v240, -v180, v240, v180
    v_fma_f32 v241, -v181, v241, v181
    v_cvt_pk_bf16_f32 v178, v240, v241
    v_mfma_f32_32x32x16_bf16 v[144:159], v[68:71], a[236:239], v[144:159]
    ds_read_b128 a[228:231], v204 offset:45056
    v_exp_f32 v240, v182
    v_exp_f32 v241, v183
    v_add_f32 v240, 1.0, v240
    v_add_f32 v241, 1.0, v241
    v_mfma_f32_32x32x16_bf16 v[128:143], v[72:75], a[240:243], v[128:143]
    s_waitcnt lgkmcnt(3)
    ds_read_b128 a[232:235], v205 offset:36864
    buffer_load_dwordx4 v[12:15], v211, s[60:63], s100 offen offset:1024 sc1
    v_fma_f32 v240, v240, v240, 1.0 div:2
    v_fma_f32 v241, v241, v241, 1.0 div:2
    v_rcp_f32 v240, v240
    v_mfma_f32_32x32x16_bf16 v[144:159], v[72:75], a[244:247], v[144:159]
    ds_read_b128 a[236:239], v205 offset:45056
    v_rcp_f32 v241, v241
    v_fma_f32 v240, -v182, v240, v182
    v_fma_f32 v241, -v183, v241, v183
    v_cvt_pk_bf16_f32 v179, v240, v241
    v_mfma_f32_32x32x16_bf16 v[128:143], v[76:79], a[248:251], v[128:143]
    s_waitcnt lgkmcnt(3)
    ds_read_b128 a[240:243], v206 offset:36864
    s_add_u32 s99, s99, 4096
    buffer_load_dwordx4 v[16:19], v211, s[60:63], s99 offen offset:0 sc1
    buffer_store_dwordx4 v[176:179], v211, s[60:63], s96 offen offset:2048 sc1
    v_mfma_f32_32x32x16_bf16 v[144:159], v[76:79], a[252:255], v[144:159]
    ds_read_b128 a[244:247], v206 offset:45056
    v_exp_f32 v240, v184
    v_exp_f32 v241, v185
    v_add_f32 v240, 1.0, v240
    v_add_f32 v241, 1.0, v241
    v_fma_f32 v240, v240, v240, 1.0 div:2
    v_fma_f32 v241, v241, v241, 1.0 div:2
    v_mfma_f32_32x32x16_bf16 v[128:143], v[80:83], a[224:227], v[128:143]
    s_waitcnt lgkmcnt(3)
    ds_read_b128 a[248:251], v207 offset:36864
    s_add_u32 s100, s100, 4096
    buffer_load_dwordx4 v[20:23], v211, s[60:63], s100 offen offset:0 sc1
    v_rcp_f32 v240, v240
    v_mfma_f32_32x32x16_bf16 v[144:159], v[80:83], a[228:231], v[144:159]
    ds_read_b128 a[252:255], v207 offset:45056
    v_rcp_f32 v241, v241
    v_fma_f32 v240, -v184, v240, v184
    v_fma_f32 v241, -v185, v241, v185
    v_cvt_pk_bf16_f32 v184, v240, v241
    v_exp_f32 v240, v186
    v_mfma_f32_32x32x16_bf16 v[128:143], v[84:87], a[232:235], v[128:143]
    s_waitcnt lgkmcnt(3)
    s_barrier
    ds_read_b128 a[224:227], v204 offset:49152
    buffer_load_dwordx4 v[24:27], v211, s[60:63], s99 offen offset:1024 sc1
    v_mfma_f32_32x32x16_bf16 v[144:159], v[84:87], a[236:239], v[144:159]
    ds_read_b128 a[228:231], v204 offset:57344
    v_exp_f32 v241, v187
    v_add_f32 v240, 1.0, v240
    v_add_f32 v241, 1.0, v241
    v_fma_f32 v240, v240, v240, 1.0 div:2
    v_fma_f32 v241, v241, v241, 1.0 div:2
    v_mfma_f32_32x32x16_bf16 v[128:143], v[88:91], a[240:243], v[128:143]
    s_waitcnt lgkmcnt(3)
    ds_read_b128 a[232:235], v205 offset:49152
    buffer_load_dwordx4 v[28:31], v211, s[60:63], s100 offen offset:1024 sc1
    v_rcp_f32 v240, v240
    v_rcp_f32 v241, v241
    v_fma_f32 v240, -v186, v240, v186
    v_mfma_f32_32x32x16_bf16 v[144:159], v[88:91], a[244:247], v[144:159]
    ds_read_b128 a[236:239], v205 offset:57344
    v_fma_f32 v241, -v187, v241, v187
    v_cvt_pk_bf16_f32 v185, v240, v241
    v_exp_f32 v240, v188
    v_exp_f32 v241, v189
    v_mfma_f32_32x32x16_bf16 v[128:143], v[92:95], a[248:251], v[128:143]
    s_waitcnt lgkmcnt(3)
    ds_read_b128 a[240:243], v206 offset:49152
    s_add_u32 s99, s99, 4096
    buffer_load_dwordx4 v[32:35], v211, s[60:63], s99 offen offset:0 sc1
    v_add_f32 v240, 1.0, v240
    v_add_f32 v241, 1.0, v241
    v_fma_f32 v240, v240, v240, 1.0 div:2
    v_mfma_f32_32x32x16_bf16 v[144:159], v[92:95], a[252:255], v[144:159]
    ds_read_b128 a[244:247], v206 offset:57344
    v_fma_f32 v241, v241, v241, 1.0 div:2
    v_rcp_f32 v240, v240
    v_rcp_f32 v241, v241
    v_fma_f32 v240, -v188, v240, v188
    v_fma_f32 v241, -v189, v241, v189
    v_mfma_f32_32x32x16_bf16 v[128:143], v[96:99], a[224:227], v[128:143]
    s_waitcnt lgkmcnt(3)
    ds_read_b128 a[248:251], v207 offset:49152
    s_add_u32 s100, s100, 4096
    buffer_load_dwordx4 v[36:39], v211, s[60:63], s100 offen offset:0 sc1
    v_cvt_pk_bf16_f32 v186, v240, v241
    v_exp_f32 v240, v190
    v_mfma_f32_32x32x16_bf16 v[144:159], v[96:99], a[228:231], v[144:159]
    ds_read_b128 a[252:255], v207 offset:57344
    v_exp_f32 v241, v191
    v_add_f32 v240, 1.0, v240
    v_add_f32 v241, 1.0, v241
    v_fma_f32 v240, v240, v240, 1.0 div:2
    v_fma_f32 v241, v241, v241, 1.0 div:2
    v_mfma_f32_32x32x16_bf16 v[128:143], v[100:103], a[232:235], v[128:143]
    s_waitcnt lgkmcnt(3)
    ds_read_b128 a[224:227], v204 offset:53248
    buffer_load_dwordx4 v[40:43], v211, s[60:63], s99 offen offset:1024 sc1
    v_rcp_f32 v240, v240
    v_rcp_f32 v241, v241
    v_mfma_f32_32x32x16_bf16 v[144:159], v[100:103], a[236:239], v[144:159]
    ds_read_b128 a[228:231], v204 offset:61440
    v_fma_f32 v240, -v190, v240, v190
    v_fma_f32 v241, -v191, v241, v191
    v_cvt_pk_bf16_f32 v187, v240, v241
    v_mfma_f32_32x32x16_bf16 v[128:143], v[104:107], a[240:243], v[128:143]
    s_waitcnt lgkmcnt(3)
    ds_read_b128 a[232:235], v205 offset:53248
    buffer_load_dwordx4 v[44:47], v211, s[60:63], s100 offen offset:1024 sc1
    buffer_load_dword v255, v253, s[60:63], s77 offen offset:1024 sc1
    buffer_store_dwordx4 v[184:187], v211, s[60:63], s96 offen offset:3072 sc1
    v_mfma_f32_32x32x16_bf16 v[144:159], v[104:107], a[244:247], v[144:159]
    ds_read_b128 a[236:239], v205 offset:61440
    v_mfma_f32_32x32x16_bf16 v[128:143], v[108:111], a[248:251], v[128:143]
    s_waitcnt lgkmcnt(3)
    ds_read_b128 a[240:243], v206 offset:53248
    s_add_u32 s99, s99, 4096
    buffer_load_dwordx4 v[48:51], v211, s[60:63], s99 offen offset:0 sc1
    v_mfma_f32_32x32x16_bf16 v[144:159], v[108:111], a[252:255], v[144:159]
    ds_read_b128 a[244:247], v206 offset:61440
    v_xor_b32 v242, 64, v239
    v_lshrrev_b32 v208, 2, v211
    v_and_b32 v208, 0x7c, v208
    v_and_b32 v247, 0x200, v211
    v_mfma_f32_32x32x16_bf16 v[128:143], v[112:115], a[224:227], v[128:143]
    s_waitcnt lgkmcnt(3)
    ds_read_b128 a[248:251], v207 offset:53248
    s_add_u32 s100, s100, 4096
    buffer_load_dwordx4 v[52:55], v211, s[60:63], s100 offen offset:0 sc1
    v_mfma_f32_32x32x16_bf16 v[144:159], v[112:115], a[228:231], v[144:159]
    ds_read_b128 a[252:255], v207 offset:61440
    v_lshl_add_u32 v208, v247, 6, v208
    v_xor_b32 v202, 16, v250
    v_xor_b32 v203, 32, v251
    v_and_b32 v246, 0x1f0, v211
    v_mfma_f32_32x32x16_bf16 v[128:143], v[116:119], a[232:235], v[128:143]
    s_waitcnt lgkmcnt(3)
    buffer_load_dwordx4 v[56:59], v211, s[60:63], s99 offen offset:1024 sc1
    v_lshl_add_u32 v246, v247, 1, v246
    v_mov_b32 v185, v252
    v_mfma_f32_32x32x16_bf16 v[144:159], v[116:119], a[236:239], v[144:159]
    s_add_u32 m0, s73, 0
    s_add_u32 s87, s93, 0
    buffer_load_dwordx4 v192, s[56:59], s87 offen offset:0  lds
    s_add_u32 s101, s73, 81920
    v_add_u32 v204, s101, v204
    v_add_u32 v205, s101, v205
    v_add_u32 v206, s101, v206
    v_add_u32 v207, s101, v207
    v_mfma_f32_32x32x16_bf16 v[128:143], v[120:123], a[240:243], v[128:143]
    s_waitcnt lgkmcnt(1)
    buffer_load_dwordx4 v[60:63], v211, s[60:63], s100 offen offset:1024 sc1
    buffer_load_dwordx4 v193, s[56:59], s87 offen offset:1024  lds
    v_mfma_f32_32x32x16_bf16 v[144:159], v[120:123], a[244:247], v[144:159]
    v_mov_b32 v187, v252
    v_mfma_f32_32x32x16_bf16 v[128:143], v[124:127], a[248:251], v[128:143]
    s_waitcnt vmcnt(20) lgkmcnt(0)
    buffer_load_dwordx4 v194, s[56:59], s87 offen offset:2048  lds
    ds_read_b64_tr_b16 v[228:229], v239 offset:0
    ds_read_b64_tr_b16 v[230:231], v242 offset:1024
    ds_read_b64_tr_b16 v[232:233], v239 offset:2048
    ds_read_b64_tr_b16 v[234:235], v242 offset:3072
    v_mfma_f32_32x32x16_bf16 v[144:159], v[124:127], a[252:255], v[144:159]
    buffer_load_dwordx4 v195, s[56:59], s87 offen offset:3072  lds
    s_nop 3
    v_pk_fma_f32 v[180:181], v[224:225], v[128:129], v[130:131] op_sel_hi:[0,1,1]
    s_nop 5
    v_pk_fma_f32 v[182:183], v[224:225], v[144:145], v[146:147] op_sel_hi:[0,1,1]
    v_pk_fma_f32 v[180:181], v[224:225], v[144:145], v[180:181] op_sel:[1,0,0] neg_lo:[1,0,0] neg_hi:[1,0,0]
    v_pk_fma_f32 v[182:183], v[224:225], v[128:129], v[182:183] op_sel:[1,0,0]
    v_pk_fma_f32 v[176:177], v[224:225], v[180:181], v[132:133] op_sel_hi:[0,1,1]
    v_pk_fma_f32 v[178:179], v[224:225], v[182:183], v[148:149] op_sel_hi:[0,1,1]
    v_pk_fma_f32 v[176:177], v[224:225], v[182:183], v[176:177] op_sel:[1,0,0] neg_lo:[1,0,0] neg_hi:[1,0,0]
    v_pk_fma_f32 v[178:179], v[224:225], v[180:181], v[178:179] op_sel:[1,0,0]
    v_pk_fma_f32 v[180:181], v[224:225], v[176:177], v[134:135] op_sel_hi:[0,1,1]
    v_pk_fma_f32 v[182:183], v[224:225], v[178:179], v[150:151] op_sel_hi:[0,1,1]
    v_pk_fma_f32 v[180:181], v[224:225], v[178:179], v[180:181] op_sel:[1,0,0] neg_lo:[1,0,0] neg_hi:[1,0,0]
    v_pk_fma_f32 v[182:183], v[224:225], v[176:177], v[182:183] op_sel:[1,0,0]
    v_pk_fma_f32 v[176:177], v[224:225], v[180:181], v[136:137] op_sel_hi:[0,1,1]
    v_pk_fma_f32 v[178:179], v[224:225], v[182:183], v[152:153] op_sel_hi:[0,1,1]
    v_pk_fma_f32 v[176:177], v[224:225], v[182:183], v[176:177] op_sel:[1,0,0] neg_lo:[1,0,0] neg_hi:[1,0,0]
    v_pk_fma_f32 v[178:179], v[224:225], v[180:181], v[178:179] op_sel:[1,0,0]
    v_pk_fma_f32 v[180:181], v[224:225], v[176:177], v[138:139] op_sel_hi:[0,1,1]
    v_pk_fma_f32 v[182:183], v[224:225], v[178:179], v[154:155] op_sel_hi:[0,1,1]
    v_pk_fma_f32 v[180:181], v[224:225], v[178:179], v[180:181] op_sel:[1,0,0] neg_lo:[1,0,0] neg_hi:[1,0,0]
    v_pk_fma_f32 v[182:183], v[224:225], v[176:177], v[182:183] op_sel:[1,0,0]
    v_pk_fma_f32 v[176:177], v[224:225], v[180:181], v[140:141] op_sel_hi:[0,1,1]
    v_pk_fma_f32 v[178:179], v[224:225], v[182:183], v[156:157] op_sel_hi:[0,1,1]
    v_pk_fma_f32 v[176:177], v[224:225], v[182:183], v[176:177] op_sel:[1,0,0] neg_lo:[1,0,0] neg_hi:[1,0,0]
    v_pk_fma_f32 v[178:179], v[224:225], v[180:181], v[178:179] op_sel:[1,0,0]
    v_pk_fma_f32 v[180:181], v[224:225], v[176:177], v[142:143] op_sel_hi:[0,1,1]
    v_pk_fma_f32 v[182:183], v[224:225], v[178:179], v[158:159] op_sel_hi:[0,1,1]
    v_pk_fma_f32 v[180:181], v[224:225], v[178:179], v[180:181] op_sel:[1,0,0] neg_lo:[1,0,0] neg_hi:[1,0,0]
    v_pk_fma_f32 v[182:183], v[224:225], v[176:177], v[182:183] op_sel:[1,0,0]
    v_fma_f32 v240, v212, v180, v181
    v_fma_f32 v241, v212, v182, v183
    v_fma_f32 v240, -v213, v182, v240
    v_fmac_f32 v241, v213, v180
    v_mul_f32 v244, v214, v240
    v_mul_f32 v245, v214, v241
    v_fma_f32 v244, -v215, v241, v244
    v_fmac_f32 v245, v215, v240
    ds_write_b64 v248, v[244:245] offset:1024
    v_mfma_f32_32x32x16_bf16 v[64:79], v[0:3], a[0:3], 0
    s_waitcnt vmcnt(8)
    s_mov_b64 exec, 1
    buffer_store_dword v252, off, s[60:63], s98 sc1
    s_mov_b64 exec, -1
    s_add_u32 s98, s98, 1024
    v_mfma_f32_32x32x16_bf16 v[80:95], v[0:3], a[4:7], 0
    s_waitcnt lgkmcnt(0)
    s_barrier
    ds_read_b128 v[160:163], v249 offset:1024
    ds_read_b128 v[164:167], v249 offset:5120
    ds_read_b128 v[168:171], v249 offset:9216
    ds_read_b128 v[172:175], v249 offset:13312
    v_mfma_f32_32x32x16_bf16 v[96:111], v[4:7], a[0:3], 0
    v_mfma_f32_32x32x16_bf16 v[112:127], v[4:7], a[4:7], 0
    v_mfma_f32_32x32x16_bf16 v[64:79], v[8:11], a[8:11], v[64:79]
    s_waitcnt lgkmcnt(0)
    v_fma_f32 v162, v216, v160, v162
    v_fma_f32 v163, v216, v161, v163
    v_fma_f32 v162, -v217, v161, v162
    v_fmac_f32 v163, v217, v160
    v_fma_f32 v164, v216, v162, v164
    v_fma_f32 v165, v216, v163, v165
    v_fma_f32 v164, -v217, v163, v164
    v_fmac_f32 v165, v217, v162
    v_fma_f32 v166, v216, v164, v166
    v_fma_f32 v167, v216, v165, v167
    v_fma_f32 v166, -v217, v165, v166
    v_fmac_f32 v167, v217, v164
    v_fma_f32 v168, v216, v166, v168
    v_fma_f32 v169, v216, v167, v169
    v_fma_f32 v168, -v217, v167, v168
    v_fmac_f32 v169, v217, v166
    v_fma_f32 v170, v216, v168, v170
    v_fma_f32 v171, v216, v169, v171
    v_fma_f32 v170, -v217, v169, v170
    v_fmac_f32 v171, v217, v168
    v_fma_f32 v172, v216, v170, v172
    v_fma_f32 v173, v216, v171, v173
    v_fma_f32 v172, -v217, v171, v172
    v_fmac_f32 v173, v217, v170
    v_fma_f32 v184, v216, v172, v174
    v_fma_f32 v186, v216, v173, v175
    v_fma_f32 v184, -v217, v173, v184
    v_fmac_f32 v186, v217, v172
    v_mfma_f32_32x32x16_bf16 v[80:95], v[8:11], a[12:15], v[80:95]
    buffer_store_dwordx4 v[184:187], v210, s[64:67], s16 offen sc1
    v_mfma_f32_32x32x16_bf16 v[96:111], v[12:15], a[8:11], v[96:111]
    v_cmp_ne_u32 vcc, s74, v255
    s_nop 0
    s_cbranch_vccnz L_sp1
L_pr1:
    v_mfma_f32_32x32x16_bf16 v[112:127], v[12:15], a[12:15], v[112:127]
    s_add_u32 s99, s99, 4294955008
    buffer_load_dwordx4 v[0:3], v211, s[60:63], s99 offen offset:2048 sc1
    v_cndmask_b32 v160, 0, v160, s[4:5]
    v_cndmask_b32 v162, v162, v164, s[4:5]
    v_mfma_f32_32x32x16_bf16 v[64:79], v[16:19], a[32:35], v[64:79]
    v_cndmask_b32 v166, v166, v168, s[4:5]
    v_cndmask_b32 v170, v170, v172, s[4:5]
    v_cndmask_b32 v160, v160, v162, s[6:7]
    v_cndmask_b32 v166, v166, v170, s[6:7]
    v_cndmask_b32 v224, v160, v166, s[8:9]
    v_mfma_f32_32x32x16_bf16 v[80:95], v[16:19], a[36:39], v[80:95]
    s_add_u32 s100, s100, 4294955008
    buffer_load_dwordx4 v[4:7], v211, s[60:63], s100 offen offset:2048 sc1
    v_cndmask_b32 v161, 0, v161, s[4:5]
    v_cndmask_b32 v163, v163, v165, s[4:5]
    v_mfma_f32_32x32x16_bf16 v[96:111], v[20:23], a[32:35], v[96:111]
    v_cndmask_b32 v167, v167, v169, s[4:5]
    v_cndmask_b32 v171, v171, v173, s[4:5]
    v_cndmask_b32 v161, v161, v163, s[6:7]
    v_cndmask_b32 v167, v167, v171, s[6:7]
    v_cndmask_b32 v225, v161, v167, s[8:9]
    v_mfma_f32_32x32x16_bf16 v[112:127], v[20:23], a[36:39], v[112:127]
    buffer_load_dwordx4 v[8:11], v211, s[60:63], s99 offen offset:3072 sc1
    v_mul_f32 v240, v215, v144
    v_mul_f32 v144, v214, v144
    v_mfma_f32_32x32x16_bf16 v[64:79], v[24:27], a[40:43], v[64:79]
    v_fmac_f32 v144, v215, v128
    v_fma_f32 v128, v214, v128, -v240
    v_mul_f32 v240, v215, v145
    v_mul_f32 v145, v214, v145
    v_fmac_f32 v145, v215, v129
    v_mfma_f32_32x32x16_bf16 v[80:95], v[24:27], a[44:47], v[80:95]
    buffer_load_dwordx4 v[12:15], v211, s[60:63], s100 offen offset:3072 sc1
    v_fma_f32 v129, v214, v129, -v240
    v_mul_f32 v240, v215, v146
    v_mfma_f32_32x32x16_bf16 v[96:111], v[28:31], a[40:43], v[96:111]
    v_mul_f32 v146, v214, v146
    v_fmac_f32 v146, v215, v130
    v_fma_f32 v130, v214, v130, -v240
    v_mul_f32 v240, v215, v147
    v_mul_f32 v147, v214, v147
    v_mfma_f32_32x32x16_bf16 v[112:127], v[28:31], a[44:47], v[112:127]
    s_add_u32 s99, s99, 4096
    buffer_load_dwordx4 v[16:19], v211, s[60:63], s99 offen offset:2048 sc1
    v_fmac_f32 v147, v215, v131
    v_fma_f32 v131, v214, v131, -v240
    v_mfma_f32_32x32x16_bf16 v[64:79], v[32:35], a[64:67], v[64:79]
    v_mul_f32 v240, v215, v148
    v_mul_f32 v148, v214, v148
    v_fmac_f32 v148, v215, v132
    v_fma_f32 v132, v214, v132, -v240
    v_mul_f32 v240, v215, v149
    v_mfma_f32_32x32x16_bf16 v[80:95], v[32:35], a[68:71], v[80:95]
    s_add_u32 s100, s100, 4096
    buffer_load_dwordx4 v[20:23], v211, s[60:63], s100 offen offset:2048 sc1
    v_mul_f32 v149, v214, v149
    v_fmac_f32 v149, v215, v133
    v_mfma_f32_32x32x16_bf16 v[96:111], v[36:39], a[64:67], v[96:111]
    ds_read_b128 a[0:3], v204 offset:49152
    v_fma_f32 v133, v214, v133, -v240
    v_mul_f32 v240, v215, v150
    v_mul_f32 v150, v214, v150
    v_fmac_f32 v150, v215, v134
    v_mfma_f32_32x32x16_bf16 v[112:127], v[36:39], a[68:71], v[112:127]
    buffer_load_dwordx4 v[24:27], v211, s[60:63], s99 offen offset:3072 sc1
    ds_read_b128 a[4:7], v205 offset:49152
    v_fma_f32 v134, v214, v134, -v240
    v_mfma_f32_32x32x16_bf16 v[64:79], v[40:43], a[72:75], v[64:79]
    ds_read_b128 a[8:11], v206 offset:49152
    v_mul_f32 v240, v215, v151
    v_mul_f32 v151, v214, v151
    v_fmac_f32 v151, v215, v135
    v_fma_f32 v135, v214, v135, -v240
    v_mfma_f32_32x32x16_bf16 v[80:95], v[40:43], a[76:79], v[80:95]
    buffer_load_dwordx4 v[28:31], v211, s[60:63], s100 offen offset:3072 sc1
    ds_read_b128 a[12:15], v207 offset:49152
    v_mul_f32 v240, v215, v152
    v_mfma_f32_32x32x16_bf16 v[96:111], v[44:47], a[72:75], v[96:111]
    s_waitcnt vmcnt(17)
    v_mul_f32 v152, v214, v152
    v_fmac_f32 v152, v215, v136
    v_fma_f32 v136, v214, v136, -v240
    v_mul_f32 v240, v215, v153
    v_mul_f32 v153, v214, v153
    v_mfma_f32_32x32x16_bf16 v[112:127], v[44:47], a[76:79], v[112:127]
    s_add_u32 s99, s99, 4096
    buffer_load_dwordx4 v[32:35], v211, s[60:63], s99 offen offset:2048 sc1
    v_fmac_f32 v153, v215, v137
    v_fma_f32 v137, v214, v137, -v240
    v_mfma_f32_32x32x16_bf16 v[64:79], v[48:51], a[96:99], v[64:79]
    s_waitcnt vmcnt(17)
    v_mul_f32 v240, v215, v154
    v_mul_f32 v154, v214, v154
    v_fmac_f32 v154, v215, v138
    v_fma_f32 v138, v214, v138, -v240
    v_mul_f32 v240, v215, v155
    v_mfma_f32_32x32x16_bf16 v[80:95], v[48:51], a[100:103], v[80:95]
    s_add_u32 s100, s100, 4096
    buffer_load_dwordx4 v[36:39], v211, s[60:63], s100 offen offset:2048 sc1
    v_mul_f32 v155, v214, v155
    v_fmac_f32 v155, v215, v139
    v_mfma_f32_32x32x16_bf16 v[96:111], v[52:55], a[96:99], v[96:111]
    s_waitcnt vmcnt(17)
    ds_read_b128 a[32:35], v204 offset:0
    v_fma_f32 v139, v214, v139, -v240
    v_mul_f32 v240, v215, v156
    v_mul_f32 v156, v214, v156
    v_fmac_f32 v156, v215, v140
    v_mfma_f32_32x32x16_bf16 v[112:127], v[52:55], a[100:103], v[112:127]
    buffer_load_dwordx4 v[40:43], v211, s[60:63], s99 offen offset:3072 sc1
    ds_read_b128 a[36:39], v205 offset:0
    v_fma_f32 v140, v214, v140, -v240
    v_mfma_f32_32x32x16_bf16 v[64:79], v[56:59], a[104:107], v[64:79]
    s_waitcnt vmcnt(16)
    ds_read_b128 a[40:43], v206 offset:0
    v_mul_f32 v240, v215, v157
    v_mul_f32 v157, v214, v157
    v_fmac_f32 v157, v215, v141
    v_fma_f32 v141, v214, v141, -v240
    v_mfma_f32_32x32x16_bf16 v[80:95], v[56:59], a[108:111], v[80:95]
    buffer_load_dwordx4 v[44:47], v211, s[60:63], s100 offen offset:3072 sc1
    ds_read_b128 a[44:47], v207 offset:0
    v_mul_f32 v240, v215, v158
    v_mfma_f32_32x32x16_bf16 v[96:111], v[60:63], a[104:107], v[96:111]
    s_waitcnt vmcnt(11)
    v_mul_f32 v158, v214, v158
    v_fmac_f32 v158, v215, v142
    v_fma_f32 v142, v214, v142, -v240
    v_mul_f32 v240, v215, v159
    v_mul_f32 v159, v214, v159
    v_mfma_f32_32x32x16_bf16 v[112:127], v[60:63], a[108:111], v[112:127]
    s_add_u32 s99, s99, 4096
    buffer_load_dwordx4 v[48:51], v211, s[60:63], s99 offen offset:2048 sc1
    buffer_load_dwordx4 v[176:179], v246, s[64:67], s21 offen offset:0 sc1
    v_mfma_f32_32x32x16_bf16 v[64:79], v[0:3], a[16:19], v[64:79]
    s_waitcnt vmcnt(12)
    buffer_load_dwordx4 v[180:183], v246, s[64:67], s21 offen offset:512 sc1
    v_fmac_f32 v159, v215, v143
    v_fma_f32 v143, v214, v143, -v240
    v_mfma_f32_32x32x16_bf16 v[80:95], v[0:3], a[20:23], v[80:95]
    s_add_u32 s100, s100, 4096
    buffer_load_dwordx4 v[52:55], v211, s[60:63], s100 offen offset:2048 sc1
    v_lshrrev_b32 v245, 8, v247
    v_lshl_add_u32 v245, s72, 2, v245
    v_mfma_f32_32x32x16_bf16 v[96:111], v[4:7], a[16:19], v[96:111]
    s_waitcnt vmcnt(13)
    ds_read_b128 a[64:67], v204 offset:16384
    buffer_load_dword v255, v253, s[60:63], s77 offen offset:2048 sc1
    v_sub_u32 v245, s75, v245
    v_mfma_f32_32x32x16_bf16 v[112:127], v[4:7], a[20:23], v[112:127]
    buffer_load_dwordx4 v[56:59], v211, s[60:63], s99 offen offset:3072 sc1
    s_add_u32 m0, s73, 16384
    s_add_u32 s87, s94, 0
    buffer_load_dwordx4 v192, s[56:59], s87 offen offset:0  lds
    ds_read_b128 a[68:71], v205 offset:16384
    v_mfma_f32_32x32x16_bf16 v[64:79], v[8:11], a[24:27], v[64:79]
    s_waitcnt vmcnt(15)
    buffer_load_dwordx4 v193, s[56:59], s87 offen offset:1024  lds
    ds_read_b128 a[72:75], v206 offset:16384
    v_med3_i32 v245, v245, 0, 2
    v_mfma_f32_32x32x16_bf16 v[80:95], v[8:11], a[28:31], v[80:95]
    buffer_load_dwordx4 v[60:63], v211, s[60:63], s100 offen offset:3072 sc1
    ds_read_b128 a[76:79], v207 offset:16384
    v_lshlrev_b32 v245, 1, v245
    v_mfma_f32_32x32x16_bf16 v[96:111], v[12:15], a[24:27], v[96:111]
    s_waitcnt vmcnt(16)
    buffer_load_dwordx4 v194, s[56:59], s87 offen offset:2048  lds
    v_mul_lo_u32 v245, v245, s74
    v_bfe_u32 v241, v211, 6, 1
    v_mfma_f32_32x32x16_bf16 v[112:127], v[12:15], a[28:31], v[112:127]
    v_bfe_u32 v242, v211, 4, 2
    v_lshl_add_u32 v242, v241, 4, v242
    v_bfe_u32 v241, v211, 7, 2
    v_lshl_add_u32 v242, v241, 2, v242
    v_mfma_f32_32x32x16_bf16 v[64:79], v[16:19], a[48:51], v[64:79]
    s_waitcnt vmcnt(16)
    buffer_load_dwordx4 v195, s[56:59], s87 offen offset:3072  lds
    s_add_u32 s88, s73, 65536
    v_lshl_add_u32 v242, v242, 3, s88
    v_lshrrev_b32 v210, 2, v247
    v_mfma_f32_32x32x16_bf16 v[80:95], v[16:19], a[52:55], v[80:95]
    v_add_u32 v210, s20, v210
    v_mfma_f32_32x32x16_bf16 v[96:111], v[20:23], a[48:51], v[96:111]
    s_waitcnt vmcnt(16)
    s_add_u32 m0, s73, 32768
    s_add_u32 s87, s93, 128
    buffer_load_dwordx4 v192, s[56:59], s87 offen offset:0  lds
    ds_read_b128 a[96:99], v204 offset:32768
    ds_write_b64 v242, v[226:227]
    v_mfma_f32_32x32x16_bf16 v[112:127], v[20:23], a[52:55], v[112:127]
    buffer_load_dwordx4 v193, s[56:59], s87 offen offset:1024  lds
    ds_read_b128 a[100:103], v205 offset:32768
    v_mfma_f32_32x32x16_bf16 v[64:79], v[24:27], a[56:59], v[64:79]
    s_waitcnt vmcnt(17)
    ds_read_b128 a[104:107], v206 offset:32768
    v_mfma_f32_32x32x16_bf16 v[80:95], v[24:27], a[60:63], v[80:95]
    s_waitcnt vmcnt(10)
    buffer_load_dwordx4 v194, s[56:59], s87 offen offset:2048  lds
    ds_read_b128 a[108:111], v207 offset:32768
    v_add_u32 v244, v177, v179
    v_add3_u32 v244, v181, v183, v244
    v_cmp_ne_u32 vcc, v244, v245
    s_nop 0
    s_cbranch_vccnz L_slb
L_rlb:
    v_fma_f32 v240, v218, v180, v176
    v_fma_f32 v241, v218, v182, v178
    v_fma_f32 v240, -v219, v182, v240
    v_fmac_f32 v241, v219, v180
    v_mul_f32 v242, v220, v240
    v_mul_f32 v243, v220, v241
    v_fma_f32 v242, -v221, v241, v242
    v_fmac_f32 v243, v221, v240
    ds_write_b64 v248, v[242:243] offset:512
    v_mfma_f32_32x32x16_bf16 v[96:111], v[28:31], a[56:59], v[96:111]
    s_waitcnt vmcnt(9)
    v_cmp_ne_u32 vcc, s74, v255
    s_nop 0
    s_cbranch_vccnz L_sp2
L_pr2:
    v_mfma_f32_32x32x16_bf16 v[112:127], v[28:31], a[60:63], v[112:127]
    s_waitcnt lgkmcnt(0)
    s_barrier
    s_nop 0
    ds_read_b128 v[160:163], v249 offset:512
    ds_read_b128 v[164:167], v249 offset:4608
    ds_read_b128 v[168:171], v249 offset:8704
    ds_read_b128 v[172:175], v249 offset:12800
    s_add_u32 s99, s99, 4096
    buffer_load_dwordx4 v[0:3], v211, s[60:63], s99 offen offset:0 sc1
    buffer_load_dwordx4 v195, s[56:59], s87 offen offset:3072  lds
    v_subrev_u32 v204, 81920, v204
    v_subrev_u32 v205, 81920, v205
    v_subrev_u32 v206, 81920, v206
    v_subrev_u32 v207, 81920, v207
    v_mfma_f32_32x32x16_bf16 v[64:79], v[32:35], a[80:83], v[64:79]
    buffer_load_dwordx4 v[4:7], v211, s[60:63], s99 offen offset:1024 sc1
    v_mfma_f32_32x32x16_bf16 v[80:95], v[32:35], a[84:87], v[80:95]
    buffer_load_dwordx4 v[8:11], v211, s[60:63], s99 offen offset:2048 sc1
    v_mfma_f32_32x32x16_bf16 v[96:111], v[36:39], a[80:83], v[96:111]
    s_waitcnt lgkmcnt(0)
    buffer_load_dwordx4 v[12:15], v211, s[60:63], s99 offen offset:3072 sc1
    ds_read_b128 a[16:19], v204 offset:0
    v_add_f32 v160, v160, v162
    v_add_f32 v161, v161, v163
    v_add_f32 v164, v164, v166
    v_add_f32 v165, v165, v167
    v_add_f32 v168, v168, v170
    v_add_f32 v169, v169, v171
    v_add_f32 v172, v172, v174
    v_add_f32 v173, v173, v175
    v_add_f32 v160, v160, v164
    v_add_f32 v161, v161, v165
    v_add_f32 v168, v168, v172
    v_add_f32 v169, v169, v173
    v_add_f32 v160, v160, v168
    v_add_f32 v161, v161, v169
    v_fma_f32 v240, v222, v160, v224
    v_fma_f32 v241, v222, v161, v225
    v_fma_f32 v240, -v223, v161, v240
    v_fmac_f32 v241, v223, v160
    v_fmac_f32 v128, v212, v240
    v_fmac_f32 v144, v212, v241
    v_fma_f32 v128, -v213, v241, v128
    v_fmac_f32 v144, v213, v240
    v_fmac_f32 v129, v212, v128
    v_fmac_f32 v145, v212, v144
    v_fma_f32 v129, -v213, v144, v129
    v_fmac_f32 v145, v213, v128
    v_fmac_f32 v130, v212, v129
    v_fmac_f32 v146, v212, v145
    v_fma_f32 v130, -v213, v145, v130
    v_fmac_f32 v146, v213, v129
    v_fmac_f32 v131, v212, v130
    v_fmac_f32 v147, v212, v146
    v_fma_f32 v131, -v213, v146, v131
    v_fmac_f32 v147, v213, v130
    v_fmac_f32 v132, v212, v131
    v_fmac_f32 v148, v212, v147
    v_fma_f32 v132, -v213, v147, v132
    v_fmac_f32 v148, v213, v131
    v_fmac_f32 v133, v212, v132
    v_fmac_f32 v149, v212, v148
    v_fma_f32 v133, -v213, v148, v133
    v_fmac_f32 v149, v213, v132
    v_fmac_f32 v134, v212, v133
    v_fmac_f32 v150, v212, v149
    v_fma_f32 v134, -v213, v149, v134
    v_fmac_f32 v150, v213, v133
    v_fmac_f32 v135, v212, v134
    v_fmac_f32 v151, v212, v150
    v_fma_f32 v135, -v213, v150, v135
    v_fmac_f32 v151, v213, v134
    v_fmac_f32 v136, v212, v135
    v_fmac_f32 v152, v212, v151
    v_fma_f32 v136, -v213, v151, v136
    v_fmac_f32_e64 v152, v213, v135
    v_cvt_pk_bf16_f32 v128, v128, v129
    v_cvt_pk_bf16_f32 v144, -v144, -v145
    v_cvt_pk_bf16_f32 v129, v130, v131
    v_cvt_pk_bf16_f32 v145, -v146, -v147
    v_cvt_pk_bf16_f32 v130, v132, v133
    v_cvt_pk_bf16_f32 v146, -v148, -v149
    v_cvt_pk_bf16_f32 v131, v134, v135
    v_cvt_pk_bf16_f32 v147, -v150, -v151
    v_fmac_f32 v137, v212, v136
    v_fmac_f32 v153, v212, v152
    v_fma_f32 v137, -v213, v152, v137
    v_fmac_f32_e64 v153, v213, v136
    v_mfma_f32_32x32x16_bf16 v[112:127], v[36:39], a[84:87], v[112:127]
    s_add_u32 s99, s99, 4096
    buffer_load_dwordx4 v[16:19], v211, s[60:63], s99 offen offset:0 sc1
    ds_read_b128 a[20:23], v205 offset:0
    ds_write_b128 v250, v[128:131]
    v_fmac_f32 v138, v212, v137
    v_fmac_f32 v154, v212, v153
    v_fma_f32 v138, -v213, v153, v138
    v_fmac_f32 v154, v213, v137
    v_fmac_f32 v139, v212, v138
    v_fmac_f32 v155, v212, v154
    v_fma_f32 v139, -v213, v154, v139
    v_fmac_f32 v155, v213, v138
    v_mfma_f32_32x32x16_bf16 v[64:79], v[40:43], a[88:91], v[64:79]
    buffer_load_dwordx4 v[20:23], v211, s[60:63], s99 offen offset:1024 sc1
    ds_read_b128 a[24:27], v206 offset:0
    ds_write_b128 v250, v[144:147] offset:2048
    v_fmac_f32 v140, v212, v139
    v_fmac_f32 v156, v212, v155
    v_fma_f32 v140, -v213, v155, v140
    v_fmac_f32 v156, v213, v139
    v_fmac_f32 v141, v212, v140
    v_fmac_f32 v157, v212, v156
    v_fma_f32 v141, -v213, v156, v141
    v_fmac_f32 v157, v213, v140
    v_fmac_f32 v142, v212, v141
    v_fmac_f32 v158, v212, v157
    v_fma_f32 v142, -v213, v157, v142
    v_fmac_f32 v158, v213, v141
    v_fmac_f32 v143, v212, v142
    v_fmac_f32 v159, v212, v158
    v_fma_f32 v143, -v213, v158, v143
    v_fmac_f32 v159, v213, v142
    v_cvt_pk_bf16_f32 v132, v136, v137
    v_cvt_pk_bf16_f32 v133, v138, v139
    v_cvt_pk_bf16_f32 v134, v140, v141
    v_cvt_pk_bf16_f32 v135, v142, v143
    v_mfma_f32_32x32x16_bf16 v[80:95], v[40:43], a[92:95], v[80:95]
    ds_read_b128 a[28:31], v207 offset:0
    ds_write_b128 v202, v[132:135]
    v_cvt_pk_bf16_f32 v148, -v152, -v153
    v_cvt_pk_bf16_f32 v149, -v154, -v155
    v_cvt_pk_bf16_f32 v150, -v156, -v157
    v_cvt_pk_bf16_f32 v151, -v158, -v159
    v_mfma_f32_32x32x16_bf16 v[96:111], v[44:47], a[88:91], v[96:111]
    buffer_load_dwordx4 v[24:27], v211, s[60:63], s99 offen offset:2048 sc1
    ds_write_b128 v202, v[148:151] offset:2048
    ds_read_b64_tr_b16 v[160:161], v251 offset:0
    ds_read_b64_tr_b16 v[162:163], v203 offset:256
    ds_read_b64_tr_b16 v[164:165], v251 offset:1024
    ds_read_b64_tr_b16 v[166:167], v203 offset:1280
    v_mfma_f32_32x32x16_bf16 v[112:127], v[44:47], a[92:95], v[112:127]
    ds_read_b64_tr_b16 v[168:169], v251 offset:2048
    ds_read_b64_tr_b16 v[170:171], v203 offset:2304
    ds_read_b64_tr_b16 v[172:173], v251 offset:3072
    ds_read_b64_tr_b16 v[174:175], v203 offset:3328
    v_mfma_f32_32x32x16_bf16 v[64:79], v[48:51], a[112:115], v[64:79]
    buffer_load_dwordx4 v[28:31], v211, s[60:63], s99 offen offset:3072 sc1
    v_mfma_f32_32x32x16_bf16 v[80:95], v[48:51], a[116:119], v[80:95]
    s_waitcnt lgkmcnt(6)
    buffer_store_dwordx4 v[160:163], v211, s[60:63], s97 offen offset:0 sc1
    v_mfma_f32_32x32x16_bf16 v[96:111], v[52:55], a[112:115], v[96:111]
    s_waitcnt vmcnt(18) lgkmcnt(4)
    s_add_u32 s99, s99, 4096
    buffer_load_dwordx4 v[32:35], v211, s[60:63], s99 offen offset:0 sc1
    buffer_store_dwordx4 v[164:167], v211, s[60:63], s97 offen offset:1024 sc1
    v_mfma_f32_32x32x16_bf16 v[112:127], v[52:55], a[116:119], v[112:127]
    s_waitcnt lgkmcnt(2)
    buffer_store_dwordx4 v[168:171], v211, s[60:63], s97 offen offset:2048 sc1
    v_mfma_f32_32x32x16_bf16 v[64:79], v[56:59], a[120:123], v[64:79]
    s_waitcnt vmcnt(16) lgkmcnt(0)
    buffer_load_dwordx4 v[36:39], v211, s[60:63], s99 offen offset:1024 sc1
    ds_read_b128 a[48:51], v204 offset:16384
    buffer_store_dwordx4 v[172:175], v211, s[60:63], s97 offen offset:3072 sc1
    v_mfma_f32_32x32x16_bf16 v[80:95], v[56:59], a[124:127], v[80:95]
    ds_read_b128 a[52:55], v205 offset:16384
    ds_read_b128 v[144:147], v210 offset:0
    ds_read_b128 v[148:151], v210 offset:16
    s_add_u32 s88, s73, 81920
    v_add_u32 v200, s88, v211
    v_mfma_f32_32x32x16_bf16 v[96:111], v[60:63], a[120:123], v[96:111]
    s_waitcnt vmcnt(14)
    buffer_load_dwordx4 v[40:43], v211, s[60:63], s99 offen offset:2048 sc1
    ds_read_b128 a[56:59], v206 offset:16384
    ds_read_b128 v[152:155], v210 offset:32
    ds_read_b128 v[156:159], v210 offset:48
    s_lshr_b32 s88, s72, 1
    s_lshl_b32 s88, s88, 14
    s_and_b32 s4, s72, 1
    s_lshl_b32 s4, s4, 11
    s_add_u32 s88, s88, s4
    s_and_b32 s4, s76, 8
    s_lshl_b32 s4, s4, 10
    s_add_u32 s88, s88, s4
    s_add_u32 s88, s88, 81920
    v_add_u32_e64 v201, s88, v211
    v_mfma_f32_32x32x16_bf16 v[112:127], v[60:63], a[124:127], v[112:127]
    ds_read_b128 a[60:63], v207 offset:16384
    ds_read_b128 v[160:163], v210 offset:64
    ds_read_b128 v[164:167], v210 offset:80
    v_xor_b32 v202, 0x2000, v201
    v_mov_b32 v245, 0x3f80
    v_mov_b32 v246, 0x3f800000
    v_mfma_f32_32x32x16_bf16 v[64:79], v[0:3], a[128:131], v[64:79]
    s_waitcnt vmcnt(13)
    buffer_load_dwordx4 v[44:47], v211, s[60:63], s99 offen offset:3072 sc1
    ds_read_b128 v[168:171], v210 offset:96
    ds_read_b128 v[172:175], v210 offset:112
    v_mfma_f32_32x32x16_bf16 v[80:95], v[0:3], a[132:135], v[80:95]
    v_mfma_f32_32x32x16_bf16 v[64:79], v[4:7], a[136:139], v[64:79]
    s_waitcnt vmcnt(13)
    s_add_u32 s100, s100, 4096
    buffer_load_dwordx4 v[48:51], v211, s[60:63], s100 offen offset:0 sc1
    v_mfma_f32_32x32x16_bf16 v[80:95], v[4:7], a[140:143], v[80:95]
    s_waitcnt lgkmcnt(9)
    ds_read_b128 a[80:83], v204 offset:32768
    v_lshlrev_b32 v212, 16, v228
    v_mul_f32 v145, v254, v145
    v_sub_f32 v144, v212, v144
    v_mul_f32 v128, v144, v145
    v_and_b32 v213, 0xffff0000, v228
    v_mfma_f32_32x32x16_bf16 v[64:79], v[8:11], a[144:147], v[64:79]
    s_waitcnt vmcnt(13)
    buffer_load_dwordx4 v[52:55], v211, s[60:63], s100 offen offset:1024 sc1
    ds_read_b128 a[84:87], v205 offset:32768
    v_mul_f32 v147, v254, v147
    v_sub_f32 v146, v213, v146
    v_mfma_f32_32x32x16_bf16 v[80:95], v[8:11], a[148:151], v[80:95]
    s_waitcnt lgkmcnt(10)
    ds_read_b128 a[88:91], v206 offset:32768
    v_mul_f32 v129, v146, v147
    v_lshlrev_b32 v214, 16, v229
    v_mul_f32 v149, v254, v149
    v_sub_f32 v148, v214, v148
    v_mul_f32 v130, v148, v149
    v_mfma_f32_32x32x16_bf16 v[64:79], v[12:15], a[152:155], v[64:79]
    s_waitcnt vmcnt(13)
    buffer_load_dwordx4 v[56:59], v211, s[60:63], s100 offen offset:2048 sc1
    ds_read_b128 a[92:95], v207 offset:32768
    v_and_b32 v215, 0xffff0000, v229
    v_mul_f32 v151, v254, v151
    v_mfma_f32_32x32x16_bf16 v[80:95], v[12:15], a[156:159], v[80:95]
    s_waitcnt lgkmcnt(10)
    v_sub_f32 v150, v215, v150
    v_mul_f32 v131, v150, v151
    v_lshlrev_b32 v216, 16, v230
    v_mul_f32 v153, v254, v153
    v_sub_f32 v152, v216, v152
    v_mul_f32 v132, v152, v153
    v_mfma_f32_32x32x16_bf16 v[64:79], v[16:19], a[160:163], v[64:79]
    s_waitcnt vmcnt(13)
    buffer_load_dwordx4 v[60:63], v211, s[60:63], s100 offen offset:3072 sc1
    v_and_b32 v217, 0xffff0000, v230
    v_mul_f32 v155, v254, v155
    v_sub_f32 v154, v217, v154
    v_mfma_f32_32x32x16_bf16 v[80:95], v[16:19], a[164:167], v[80:95]
    s_waitcnt lgkmcnt(9)
    v_mul_f32 v133, v154, v155
    v_lshlrev_b32 v218, 16, v231
    v_mul_f32 v157, v254, v157
    v_sub_f32 v156, v218, v156
    v_mul_f32 v134, v156, v157
    v_and_b32 v219, 0xffff0000, v231
    v_mfma_f32_32x32x16_bf16 v[64:79], v[20:23], a[168:171], v[64:79]
    s_waitcnt vmcnt(13)
    s_add_u32 s100, s100, 4096
    buffer_load_dwordx4 v[0:3], v211, s[60:63], s100 offen offset:0 sc1
    v_mul_f32 v159, v254, v159
    v_sub_f32 v158, v219, v158
    v_mfma_f32_32x32x16_bf16 v[80:95], v[20:23], a[172:175], v[80:95]
    s_waitcnt lgkmcnt(7)
    buffer_load_dwordx4 v[4:7], v211, s[60:63], s100 offen offset:1024 sc1
    v_mul_f32 v135, v158, v159
    v_lshlrev_b32 v220, 16, v232
    v_mul_f32 v161, v254, v161
    v_sub_f32 v160, v220, v160
    v_mfma_f32_32x32x16_bf16 v[64:79], v[24:27], a[176:179], v[64:79]
    s_waitcnt vmcnt(14)
    buffer_load_dwordx4 v[8:11], v211, s[60:63], s100 offen offset:2048 sc1
    v_mul_f32 v136, v160, v161
    v_and_b32 v221, 0xffff0000, v232
    v_mul_f32 v163, v254, v163
    v_mfma_f32_32x32x16_bf16 v[80:95], v[24:27], a[180:183], v[80:95]
    buffer_load_dwordx4 v[12:15], v211, s[60:63], s100 offen offset:3072 sc1
    v_sub_f32 v162, v221, v162
    v_mul_f32 v137, v162, v163
    v_lshlrev_b32 v222, 16, v233
    v_mfma_f32_32x32x16_bf16 v[64:79], v[28:31], a[184:187], v[64:79]
    s_waitcnt vmcnt(14) lgkmcnt(6)
    s_add_u32 s100, s100, 4096
    buffer_load_dwordx4 v[16:19], v211, s[60:63], s100 offen offset:0 sc1
    v_mul_f32 v165, v254, v165
    v_sub_f32 v164, v222, v164
    v_mfma_f32_32x32x16_bf16 v[80:95], v[28:31], a[188:191], v[80:95]
    buffer_load_dwordx4 v[20:23], v211, s[60:63], s100 offen offset:1024 sc1
    v_mul_f32 v138, v164, v165
    v_and_b32 v223, 0xffff0000, v233
    v_mul_f32 v167, v254, v167
    v_mfma_f32_32x32x16_bf16 v[64:79], v[32:35], a[192:195], v[64:79]
    s_waitcnt vmcnt(13)
    buffer_load_dwordx4 v[24:27], v211, s[60:63], s100 offen offset:2048 sc1
    v_sub_f32 v166, v223, v166
    v_mul_f32 v139, v166, v167
    v_lshlrev_b32 v224, 16, v234
    v_mfma_f32_32x32x16_bf16 v[80:95], v[32:35], a[196:199], v[80:95]
    s_waitcnt lgkmcnt(5)
    buffer_load_dwordx4 v[28:31], v211, s[60:63], s100 offen offset:3072 sc1
    v_mul_f32 v169, v254, v169
    v_sub_f32 v168, v224, v168
    v_mul_f32 v140, v168, v169
    v_mfma_f32_32x32x16_bf16 v[64:79], v[36:39], a[200:203], v[64:79]
    s_waitcnt vmcnt(13) lgkmcnt(4)
    v_and_b32 v225, 0xffff0000, v234
    v_mul_f32 v171, v254, v171
    v_sub_f32 v170, v225, v170
    v_mul_f32 v141, v170, v171
    v_lshlrev_b32 v226, 16, v235
    v_mul_f32 v173, v254, v173
    v_mfma_f32_32x32x16_bf16 v[80:95], v[36:39], a[204:207], v[80:95]
    s_mov_b64 exec, 1
    buffer_store_dword v252, off, s[60:63], s98 sc1
    s_mov_b64 exec, -1
    s_add_u32 s98, s98, 1024
    v_mfma_f32_32x32x16_bf16 v[64:79], v[40:43], a[208:211], v[64:79]
    s_waitcnt vmcnt(13)
    v_sub_f32 v172, v226, v172
    v_mul_f32 v142, v172, v173
    v_and_b32 v227, 0xffff0000, v235
    v_mul_f32 v175, v254, v175
    v_sub_f32 v174, v227, v174
    v_mul_f32 v143, v174, v175
    v_mfma_f32_32x32x16_bf16 v[80:95], v[40:43], a[212:215], v[80:95]
    v_mfma_f32_32x32x16_bf16 v[64:79], v[44:47], a[216:219], v[64:79]
    s_waitcnt vmcnt(12)
    v_mfma_f32_32x32x16_bf16 v[80:95], v[44:47], a[220:223], v[80:95]
    v_mfma_f32_32x32x16_bf16 v[96:111], v[48:51], a[128:131], v[96:111]
    s_waitcnt vmcnt(11)
    v_mfma_f32_32x32x16_bf16 v[112:127], v[48:51], a[132:135], v[112:127]
    s_nop 6
    v_cvt_pk_bf16_f32 v64, v64, v65
    v_cvt_pk_bf16_f32 v65, v66, v67
    v_cvt_pk_bf16_f32 v66, v68, v69
    v_cvt_pk_bf16_f32 v67, v70, v71
    v_mfma_f32_32x32x16_bf16 v[96:111], v[52:55], a[136:139], v[96:111]
    s_waitcnt vmcnt(10)
    v_cvt_pk_bf16_f32 v68, v72, v73
    v_cvt_pk_bf16_f32 v69, v74, v75
    v_cvt_pk_bf16_f32 v70, v76, v77
    v_cvt_pk_bf16_f32 v71, v78, v79
    v_mfma_f32_32x32x16_bf16 v[112:127], v[52:55], a[140:143], v[112:127]
    ds_write_b128 v200, v[64:67] offset:0
    v_mfma_f32_32x32x16_bf16 v[96:111], v[56:59], a[144:147], v[96:111]
    s_waitcnt vmcnt(9)
    v_mfma_f32_32x32x16_bf16 v[112:127], v[56:59], a[148:151], v[112:127]
    ds_write_b128 v200, v[68:71] offset:1024
    v_cvt_pk_bf16_f32 v80, v80, v81
    v_cvt_pk_bf16_f32 v81, v82, v83
    v_cvt_pk_bf16_f32 v82, v84, v85
    v_cvt_pk_bf16_f32 v83, v86, v87
    v_mfma_f32_32x32x16_bf16 v[96:111], v[60:63], a[152:155], v[96:111]
    s_waitcnt vmcnt(8)
    v_cvt_pk_bf16_f32 v84, v88, v89
    v_cvt_pk_bf16_f32 v85, v90, v91
    v_cvt_pk_bf16_f32 v86, v92, v93
    v_cvt_pk_bf16_f32 v87, v94, v95
    v_mfma_f32_32x32x16_bf16 v[112:127], v[60:63], a[156:159], v[112:127]
    ds_write_b128 v200, v[80:83] offset:2048
    v_mfma_f32_32x32x16_bf16 v[96:111], v[0:3], a[160:163], v[96:111]
    s_waitcnt vmcnt(6)
    v_mfma_f32_32x32x16_bf16 v[96:111], v[4:7], a[168:171], v[96:111]
    ds_write_b128 v200, v[84:87] offset:3072
    v_mfma_f32_32x32x16_bf16 v[96:111], v[8:11], a[176:179], v[96:111]
    s_waitcnt vmcnt(4)
    s_add_u32 m0, s73, 49152
    s_add_u32 s87, s94, 128
    buffer_load_dwordx4 v192, s[56:59], s87 offen offset:0  lds
    v_mfma_f32_32x32x16_bf16 v[96:111], v[12:15], a[184:187], v[96:111]
    v_mfma_f32_32x32x16_bf16 v[96:111], v[16:19], a[192:195], v[96:111]
    s_waitcnt vmcnt(3)
    buffer_load_dwordx4 v193, s[56:59], s87 offen offset:1024  lds
    v_mfma_f32_32x32x16_bf16 v[96:111], v[20:23], a[200:203], v[96:111]
    v_mfma_f32_32x32x16_bf16 v[96:111], v[24:27], a[208:211], v[96:111]
    s_waitcnt vmcnt(3)
    buffer_load_dwordx4 v194, s[56:59], s87 offen offset:2048  lds
    v_mfma_f32_32x32x16_bf16 v[96:111], v[28:31], a[216:219], v[96:111]
    v_mfma_f32_32x32x16_bf16 v[112:127], v[0:3], a[164:167], v[112:127]
    buffer_load_dwordx4 v195, s[56:59], s87 offen offset:3072  lds
    v_mfma_f32_32x32x16_bf16 v[112:127], v[4:7], a[172:175], v[112:127]
    v_mfma_f32_32x32x16_bf16 v[112:127], v[8:11], a[180:183], v[112:127]
    s_nop 7
    v_cvt_pk_bf16_f32 v96, v96, v97
    v_cvt_pk_bf16_f32 v97, v98, v99
    v_cvt_pk_bf16_f32 v98, v100, v101
    v_cvt_pk_bf16_f32 v99, v102, v103
    v_mfma_f32_32x32x16_bf16 v[112:127], v[12:15], a[188:191], v[112:127]
    v_cvt_pk_bf16_f32 v100, v104, v105
    v_cvt_pk_bf16_f32 v101, v106, v107
    v_cvt_pk_bf16_f32 v102, v108, v109
    v_cvt_pk_bf16_f32 v103, v110, v111
    v_mfma_f32_32x32x16_bf16 v[112:127], v[16:19], a[196:199], v[112:127]
    ds_write_b128 v200, v[96:99] offset:16384
    v_mfma_f32_32x32x16_bf16 v[112:127], v[20:23], a[204:207], v[112:127]
    v_mfma_f32_32x32x16_bf16 v[112:127], v[24:27], a[212:215], v[112:127]
    ds_write_b128 v200, v[100:103] offset:17408
    v_mfma_f32_32x32x16_bf16 v[112:127], v[28:31], a[220:223], v[112:127]
    s_nop 11
    v_cvt_pk_bf16_f32 v112, v112, v113
    v_cvt_pk_bf16_f32 v113, v114, v115
    v_cvt_pk_bf16_f32 v114, v116, v117
    v_cvt_pk_bf16_f32 v115, v118, v119
    v_cvt_pk_bf16_f32 v116, v120, v121
    v_cvt_pk_bf16_f32 v117, v122, v123
    v_cvt_pk_bf16_f32 v118, v124, v125
    v_cvt_pk_bf16_f32 v119, v126, v127
    ds_write_b128 v200, v[112:115] offset:18432
    ds_write_b128 v200, v[116:119] offset:19456
    s_waitcnt lgkmcnt(0)
    s_barrier
    ds_read_b128 v[0:3], v202 offset:0
    ds_read_b128 v[4:7], v202 offset:1024
    ds_read_b128 v[8:11], v202 offset:4096
    ds_read_b128 v[12:15], v202 offset:5120
    ds_read_b128 v[16:19], v201 offset:0
    ds_read_b128 v[20:23], v201 offset:1024
    ds_read_b128 v[24:27], v201 offset:4096
    ds_read_b128 v[28:31], v201 offset:5120
    buffer_load_dword v255, v253, s[60:63], s18 offen offset:0 sc1
    s_waitcnt lgkmcnt(7)
    s_nop 0
    v_dot2_f32_bf16 v48, v0, v245, 0
    v_dot2_f32_bf16 v49, v0, v246, 0
    v_dot2_f32_bf16 v50, v1, v245, 0
    v_dot2_f32_bf16 v51, v1, v246, 0
    v_dot2_f32_bf16 v52, v2, v245, 0
    v_dot2_f32_bf16 v53, v2, v246, 0
    v_dot2_f32_bf16 v54, v3, v245, 0
    v_dot2_f32_bf16 v55, v3, v246, 0
    s_waitcnt lgkmcnt(6)
    s_nop 0
    v_dot2_f32_bf16 v56, v4, v245, 0
    v_dot2_f32_bf16 v57, v4, v246, 0
    v_dot2_f32_bf16 v58, v5, v245, 0
    v_dot2_f32_bf16 v59, v5, v246, 0
    v_dot2_f32_bf16 v60, v6, v245, 0
    v_dot2_f32_bf16 v61, v6, v246, 0
    v_dot2_f32_bf16 v62, v7, v245, 0
    v_dot2_f32_bf16 v63, v7, v246, 0
    s_waitcnt lgkmcnt(5)
    s_nop 0
    v_dot2_f32_bf16 v48, v8, v245, v48
    v_dot2_f32_bf16 v49, v8, v246, v49
    v_dot2_f32_bf16 v50, v9, v245, v50
    v_dot2_f32_bf16 v51, v9, v246, v51
    v_dot2_f32_bf16 v52, v10, v245, v52
    v_dot2_f32_bf16 v53, v10, v246, v53
    v_dot2_f32_bf16 v54, v11, v245, v54
    v_dot2_f32_bf16 v55, v11, v246, v55
    s_waitcnt lgkmcnt(4)
    s_nop 0
    v_dot2_f32_bf16 v56, v12, v245, v56
    v_dot2_f32_bf16 v57, v12, v246, v57
    v_dot2_f32_bf16 v58, v13, v245, v58
    v_dot2_f32_bf16 v59, v13, v246, v59
    v_dot2_f32_bf16 v60, v14, v245, v60
    v_dot2_f32_bf16 v61, v14, v246, v61
    v_dot2_f32_bf16 v62, v15, v245, v62
    v_dot2_f32_bf16 v63, v15, v246, v63
    v_cvt_pk_bf16_f32 v64, v48, v49
    v_cvt_pk_bf16_f32 v65, v50, v51
    v_cvt_pk_bf16_f32 v66, v52, v53
    v_cvt_pk_bf16_f32 v67, v54, v55
    v_cvt_pk_bf16_f32 v68, v56, v57
    v_cvt_pk_bf16_f32 v69, v58, v59
    v_cvt_pk_bf16_f32 v70, v60, v61
    v_cvt_pk_bf16_f32 v71, v62, v63
    s_waitcnt vmcnt(0)
    v_cmp_ne_u32 vcc, s74, v255
    s_nop 0
    s_cbranch_vccnz L_sp3
L_pr3:
    buffer_load_dwordx4 a[224:227], v211, s[60:63], s11 offen offset:0 sc1
    buffer_load_dwordx4 a[228:231], v211, s[60:63], s11 offen offset:1024 sc1
    buffer_store_dwordx4 v[64:67], v211, s[60:63], s12 offen offset:0 sc1
    buffer_load_dwordx4 a[232:235], v211, s[60:63], s11 offen offset:2048 sc1
    buffer_load_dwordx4 a[236:239], v211, s[60:63], s11 offen offset:3072 sc1
    buffer_store_dwordx4 v[68:71], v211, s[60:63], s12 offen offset:1024 sc1
    s_add_u32 s11, s11, 4096
    buffer_load_dwordx4 a[240:243], v211, s[60:63], s11 offen offset:0 sc1
    buffer_load_dwordx4 a[244:247], v211, s[60:63], s11 offen offset:1024 sc1
    ds_read_b128 a[112:115], v204 offset:49152
    buffer_load_dwordx4 a[248:251], v211, s[60:63], s11 offen offset:2048 sc1
    buffer_load_dwordx4 a[252:255], v211, s[60:63], s11 offen offset:3072 sc1
    ds_read_b128 a[116:119], v205 offset:49152
    s_add_u32 s11, s11, 4096
    buffer_load_dwordx4 a[128:131], v211, s[60:63], s11 offen offset:0 sc1
    buffer_load_dwordx4 a[132:135], v211, s[60:63], s11 offen offset:1024 sc1
    ds_read_b128 a[120:123], v206 offset:49152
    ds_read_b128 a[124:127], v207 offset:49152
    s_waitcnt vmcnt(11)
    v_mfma_f32_32x32x16_bf16 v[176:191], a[224:227], a[32:35], 0
    v_mfma_f32_32x32x16_bf16 v[160:175], a[224:227], a[0:3], 0
    s_waitcnt vmcnt(10)
    buffer_load_dwordx4 a[136:139], v211, s[60:63], s11 offen offset:2048 sc1
    v_mfma_f32_32x32x16_bf16 v[176:191], a[228:231], a[36:39], v[176:191]
    s_waitcnt lgkmcnt(5)
    v_lshlrev_b32 v32, 16, v16
    v_and_b32 v33, 0xffff0000, v16
    v_lshlrev_b32 v48, 16, v24
    v_and_b32 v49, 0xffff0000, v24
    v_add_f32 v32, v32, v48
    v_mfma_f32_32x32x16_bf16 v[160:175], a[228:231], a[4:7], v[160:175]
    s_waitcnt vmcnt(9)
    buffer_load_dwordx4 a[140:143], v211, s[60:63], s11 offen offset:3072 sc1
    v_add_f32 v33, v33, v49
    v_lshlrev_b32 v34, 16, v17
    v_mfma_f32_32x32x16_bf16 v[176:191], a[232:235], a[48:51], v[176:191]
    v_and_b32 v35, 0xffff0000, v17
    v_lshlrev_b32 v48, 16, v25
    v_and_b32 v49, 0xffff0000, v25
    v_add_f32 v34, v34, v48
    v_mfma_f32_32x32x16_bf16 v[160:175], a[232:235], a[16:19], v[160:175]
    s_waitcnt vmcnt(9)
    s_add_u32 s11, s11, 4096
    buffer_load_dwordx4 a[144:147], v211, s[60:63], s11 offen offset:0 sc1
    v_add_f32 v35, v35, v49
    v_lshlrev_b32 v36, 16, v18
    v_mfma_f32_32x32x16_bf16 v[176:191], a[236:239], a[52:55], v[176:191]
    v_and_b32 v37, 0xffff0000, v18
    v_lshlrev_b32 v48, 16, v26
    v_and_b32 v49, 0xffff0000, v26
    v_add_f32 v36, v36, v48
    v_add_f32 v37, v37, v49
    v_mfma_f32_32x32x16_bf16 v[160:175], a[236:239], a[20:23], v[160:175]
    s_waitcnt vmcnt(8)
    buffer_load_dwordx4 a[148:151], v211, s[60:63], s11 offen offset:1024 sc1
    v_lshlrev_b32 v38, 16, v19
    v_and_b32 v39, 0xffff0000, v19
    v_mfma_f32_32x32x16_bf16 v[176:191], a[240:243], a[40:43], v[176:191]
    s_mov_b64 exec, 1
    buffer_store_dword v252, off, s[60:63], s98 sc1
    s_mov_b64 exec, -1
    s_add_u32 s98, s98, 1024
    v_mfma_f32_32x32x16_bf16 v[160:175], a[240:243], a[8:11], v[160:175]
    s_waitcnt vmcnt(9)
    buffer_load_dwordx4 a[152:155], v211, s[60:63], s11 offen offset:2048 sc1
    v_lshlrev_b32 v48, 16, v27
    v_and_b32 v49, 0xffff0000, v27
    v_mfma_f32_32x32x16_bf16 v[176:191], a[244:247], a[44:47], v[176:191]
    v_add_f32 v38, v38, v48
    v_add_f32 v39, v39, v49
    v_lshlrev_b32 v40, 16, v20
    v_and_b32 v41, 0xffff0000, v20
    v_mfma_f32_32x32x16_bf16 v[160:175], a[244:247], a[12:15], v[160:175]
    s_waitcnt vmcnt(9) lgkmcnt(4)
    buffer_load_dwordx4 a[156:159], v211, s[60:63], s11 offen offset:3072 sc1
    v_lshlrev_b32 v48, 16, v28
    v_and_b32 v49, 0xffff0000, v28
    v_mfma_f32_32x32x16_bf16 v[176:191], a[248:251], a[56:59], v[176:191]
    v_add_f32 v40, v40, v48
    v_add_f32 v41, v41, v49
    v_lshlrev_b32 v42, 16, v21
    v_and_b32 v43, 0xffff0000, v21
    v_lshlrev_b32 v48, 16, v29
    v_mfma_f32_32x32x16_bf16 v[160:175], a[248:251], a[24:27], v[160:175]
    s_waitcnt vmcnt(9)
    buffer_load_dwordx4 a[160:163], v211, s[60:63], s10 offen offset:0 sc1
    v_and_b32 v49, 0xffff0000, v29
    v_add_f32 v42, v42, v48
    v_mfma_f32_32x32x16_bf16 v[176:191], a[252:255], a[60:63], v[176:191]
    v_add_f32 v43, v43, v49
    v_lshlrev_b32 v44, 16, v22
    v_and_b32 v45, 0xffff0000, v22
    v_lshlrev_b32 v48, 16, v30
    v_and_b32 v49, 0xffff0000, v30
    v_mfma_f32_32x32x16_bf16 v[160:175], a[252:255], a[28:31], v[160:175]
    s_waitcnt vmcnt(9)
    buffer_load_dwordx4 a[164:167], v211, s[60:63], s10 offen offset:1024 sc1
    v_add_f32 v44, v44, v48
    v_mfma_f32_32x32x16_bf16 v[176:191], a[128:131], a[96:99], v[176:191]
    v_add_f32 v45, v45, v49
    v_lshlrev_b32 v46, 16, v23
    v_and_b32 v47, 0xffff0000, v23
    v_lshlrev_b32 v48, 16, v31
    v_and_b32 v49, 0xffff0000, v31
    v_mfma_f32_32x32x16_bf16 v[160:175], a[128:131], a[64:67], v[160:175]
    s_waitcnt vmcnt(9)
    buffer_load_dwordx4 a[168:171], v211, s[60:63], s10 offen offset:2048 sc1
    v_add_f32 v46, v46, v48
    v_add_f32 v47, v47, v49
    v_mfma_f32_32x32x16_bf16 v[176:191], a[132:135], a[100:103], v[176:191]
    v_mfma_f32_32x32x16_bf16 v[160:175], a[132:135], a[68:71], v[160:175]
    s_waitcnt vmcnt(9) lgkmcnt(3)
    buffer_load_dwordx4 a[172:175], v211, s[60:63], s10 offen offset:3072 sc1
    v_mfma_f32_32x32x16_bf16 v[176:191], a[136:139], a[112:115], v[176:191]
    v_add_u32 v192, s73, v211
    v_xor_b32 v193, 4096, v192
    v_xor_b32 v194, 8192, v192
    v_xor_b32 v195, 12288, v192
    v_mfma_f32_32x32x16_bf16 v[160:175], a[136:139], a[80:83], v[160:175]
    s_waitcnt vmcnt(9) lgkmcnt(2)
    s_add_u32 s10, s10, 4096
    buffer_load_dwordx4 a[176:179], v211, s[60:63], s10 offen offset:0 sc1
    v_mfma_f32_32x32x16_bf16 v[176:191], a[140:143], a[116:119], v[176:191]
    v_mfma_f32_32x32x16_bf16 v[160:175], a[140:143], a[84:87], v[160:175]
    s_waitcnt vmcnt(9)
    buffer_load_dwordx4 a[180:183], v211, s[60:63], s10 offen offset:1024 sc1
    v_mfma_f32_32x32x16_bf16 v[176:191], a[144:147], a[104:107], v[176:191]
    v_mfma_f32_32x32x16_bf16 v[160:175], a[144:147], a[72:75], v[160:175]
    s_waitcnt vmcnt(9)
    buffer_load_dwordx4 a[184:187], v211, s[60:63], s10 offen offset:2048 sc1
    v_mfma_f32_32x32x16_bf16 v[176:191], a[148:151], a[108:111], v[176:191]
    v_mfma_f32_32x32x16_bf16 v[160:175], a[148:151], a[76:79], v[160:175]
    s_waitcnt vmcnt(8) lgkmcnt(1)
    buffer_load_dwordx4 a[188:191], v211, s[60:63], s10 offen offset:3072 sc1
    v_mfma_f32_32x32x16_bf16 v[176:191], a[152:155], a[120:123], v[176:191]
    v_mfma_f32_32x32x16_bf16 v[160:175], a[152:155], a[88:91], v[160:175]
    s_waitcnt vmcnt(8) lgkmcnt(0)
    s_add_u32 s10, s10, 4096
    buffer_load_dwordx4 a[192:195], v211, s[60:63], s10 offen offset:0 sc1
    v_mfma_f32_32x32x16_bf16 v[176:191], a[156:159], a[124:127], v[176:191]
    v_mfma_f32_32x32x16_bf16 v[160:175], a[156:159], a[92:95], v[160:175]
    s_waitcnt vmcnt(8)
    buffer_load_dwordx4 a[196:199], v211, s[60:63], s10 offen offset:1024 sc1
    v_mfma_f32_32x32x16_bf16 v[144:159], a[160:163], a[32:35], 0
    buffer_load_dword v255, off, s[60:63], s19 offset:0 sc1
    v_mfma_f32_32x32x16_bf16 v[128:143], a[160:163], a[0:3], v[128:143]
    s_waitcnt vmcnt(9)
    buffer_load_dwordx4 a[200:203], v211, s[60:63], s10 offen offset:2048 sc1
    v_mfma_f32_32x32x16_bf16 v[144:159], a[164:167], a[36:39], v[144:159]
    v_mfma_f32_32x32x16_bf16 v[128:143], a[164:167], a[4:7], v[128:143]
    s_waitcnt vmcnt(9)
    buffer_load_dwordx4 a[204:207], v211, s[60:63], s10 offen offset:3072 sc1
    ds_write_b128 v192, v[176:179] offset:32768
    v_mfma_f32_32x32x16_bf16 v[144:159], a[168:171], a[48:51], v[144:159]
    ds_write_b128 v192, v[180:183] offset:33792
    v_mfma_f32_32x32x16_bf16 v[128:143], a[168:171], a[16:19], v[128:143]
    s_waitcnt vmcnt(9)
    s_add_u32 s10, s10, 4096
    buffer_load_dwordx4 a[208:211], v211, s[60:63], s10 offen offset:0 sc1
    v_mfma_f32_32x32x16_bf16 v[144:159], a[172:175], a[52:55], v[144:159]
    ds_write_b128 v192, v[184:187] offset:34816
    v_mfma_f32_32x32x16_bf16 v[128:143], a[172:175], a[20:23], v[128:143]
    s_waitcnt vmcnt(9)
    buffer_load_dwordx4 a[212:215], v211, s[60:63], s10 offen offset:1024 sc1
    v_mfma_f32_32x32x16_bf16 v[144:159], a[176:179], a[40:43], v[144:159]
    ds_write_b128 v192, v[188:191] offset:35840
    v_mfma_f32_32x32x16_bf16 v[128:143], a[176:179], a[8:11], v[128:143]
    s_waitcnt vmcnt(9)
    buffer_load_dwordx4 a[216:219], v211, s[60:63], s10 offen offset:2048 sc1
    v_mfma_f32_32x32x16_bf16 v[144:159], a[180:183], a[44:47], v[144:159]
    ds_write_b128 v192, v[160:163] offset:16384
    v_mfma_f32_32x32x16_bf16 v[128:143], a[180:183], a[12:15], v[128:143]
    s_waitcnt vmcnt(9)
    buffer_load_dwordx4 a[220:223], v211, s[60:63], s10 offen offset:3072 sc1
    ds_write_b128 v192, v[164:167] offset:17408
    v_mfma_f32_32x32x16_bf16 v[144:159], a[184:187], a[56:59], v[144:159]
    v_mfma_f32_32x32x16_bf16 v[128:143], a[184:187], a[24:27], v[128:143]
    s_waitcnt vmcnt(9)
    ds_write_b128 v192, v[168:171] offset:18432
    v_mfma_f32_32x32x16_bf16 v[144:159], a[188:191], a[60:63], v[144:159]
    s_waitcnt vmcnt(6)
    v_cmp_ne_u32 vcc, s74, v255
    s_nop 0
    s_cbranch_vccnz L_sp4
L_pr4:
    v_mfma_f32_32x32x16_bf16 v[144:159], a[192:195], a[96:99], v[144:159]
    buffer_load_dwordx4 v[0:3], v211, s[60:63], s13 offen offset:0 sc1
    ds_write_b128 v192, v[172:175] offset:19456
    v_mfma_f32_32x32x16_bf16 v[144:159], a[196:199], a[100:103], v[144:159]
    s_waitcnt vmcnt(6)
    buffer_load_dwordx4 v[4:7], v211, s[60:63], s13 offen offset:1024 sc1
    v_mfma_f32_32x32x16_bf16 v[144:159], a[200:203], a[112:115], v[144:159]
    s_waitcnt vmcnt(6)
    v_mfma_f32_32x32x16_bf16 v[144:159], a[204:207], a[116:119], v[144:159]
    s_waitcnt vmcnt(5)
    v_mfma_f32_32x32x16_bf16 v[144:159], a[208:211], a[104:107], v[144:159]
    s_waitcnt vmcnt(4) lgkmcnt(0)
    s_barrier
    ds_read_b128 v[160:163], v194 offset:16384
    ds_read_b128 v[164:167], v194 offset:17408
    v_mfma_f32_32x32x16_bf16 v[144:159], a[212:215], a[108:111], v[144:159]
    s_waitcnt vmcnt(3)
    ds_read_b128 v[168:171], v194 offset:18432
    ds_read_b128 v[172:175], v194 offset:19456
    v_mfma_f32_32x32x16_bf16 v[144:159], a[216:219], a[120:123], v[144:159]
    s_waitcnt vmcnt(2)
    ds_read_b128 v[176:179], v195 offset:32768
    ds_read_b128 v[180:183], v195 offset:33792
    v_mfma_f32_32x32x16_bf16 v[144:159], a[220:223], a[124:127], v[144:159]
    ds_read_b128 v[184:187], v195 offset:34816
    ds_read_b128 v[188:191], v195 offset:35840
    v_mfma_f32_32x32x16_bf16 v[128:143], a[188:191], a[28:31], v[128:143]
    v_mfma_f32_32x32x16_bf16 v[128:143], a[192:195], a[64:67], v[128:143]
    v_mfma_f32_32x32x16_bf16 v[128:143], a[196:199], a[68:71], v[128:143]
    s_nop 6
    ds_write_b128 v192, v[144:147] offset:0
    v_mfma_f32_32x32x16_bf16 v[128:143], a[200:203], a[80:83], v[128:143]
    s_waitcnt lgkmcnt(4)
    ds_write_b128 v192, v[148:151] offset:1024
    v_add_f32 v160, v160, v176
    v_add_f32 v161, v161, v177
    v_add_f32 v162, v162, v178
    v_mfma_f32_32x32x16_bf16 v[128:143], a[204:207], a[84:87], v[128:143]
    s_waitcnt lgkmcnt(4)
    ds_write_b128 v192, v[152:155] offset:2048
    v_add_f32 v163, v163, v179
    v_add_f32 v164, v164, v180
    v_mfma_f32_32x32x16_bf16 v[128:143], a[208:211], a[72:75], v[128:143]
    s_waitcnt vmcnt(1)
    ds_write_b128 v192, v[156:159] offset:3072
    v_add_f32 v165, v165, v181
    v_add_f32 v166, v166, v182
    v_add_f32 v167, v167, v183
    v_lshlrev_b32 v48, 16, v0
    v_and_b32 v49, 0xffff0000, v0
    v_add_f32 v32, v32, v48
    v_add_f32 v33, v33, v49
    v_mfma_f32_32x32x16_bf16 v[128:143], a[212:215], a[76:79], v[128:143]
    s_waitcnt lgkmcnt(5)
    v_add_f32 v168, v168, v184
    v_add_f32 v169, v169, v185
    v_add_f32 v170, v170, v186
    v_exp_f32 v48, -v32
    v_exp_f32 v49, -v33
    v_add_f32 v48, 1.0, v48
    v_add_f32 v49, 1.0, v49
    v_rcp_f32 v48, v48
    v_rcp_f32 v49, v49
    v_mfma_f32_32x32x16_bf16 v[128:143], a[216:219], a[88:91], v[128:143]
    s_waitcnt lgkmcnt(4)
    v_add_f32 v171, v171, v187
    v_add_f32 v172, v172, v188
    v_mul_f32 v32, v32, v48
    v_mul_f32 v33, v33, v49
    v_lshlrev_b32 v48, 16, v1
    v_and_b32 v49, 0xffff0000, v1
    v_add_f32 v34, v34, v48
    v_add_f32 v35, v35, v49
    v_exp_f32 v48, -v34
    v_exp_f32 v49, -v35
    v_mfma_f32_32x32x16_bf16 v[128:143], a[220:223], a[92:95], v[128:143]
    v_add_f32 v173, v173, v189
    v_add_f32 v174, v174, v190
    v_add_f32 v175, v175, v191
    v_add_f32 v48, 1.0, v48
    v_add_f32 v49, 1.0, v49
    v_rcp_f32 v48, v48
    v_rcp_f32 v49, v49
    v_mul_f32 v34, v34, v48
    v_mul_f32 v35, v35, v49
    s_waitcnt lgkmcnt(0)
    s_barrier
    s_nop 0
    ds_read_b128 v[144:147], v193 offset:0
    ds_read_b128 v[148:151], v193 offset:1024
    ds_read_b128 v[152:155], v193 offset:2048
    ds_read_b128 v[156:159], v193 offset:3072
    v_pk_add_f32 v[128:129], v[128:129], v[160:161]
    v_pk_add_f32 v[130:131], v[130:131], v[162:163]
    s_waitcnt lgkmcnt(3)
    s_nop 0
    v_pk_add_f32 v[128:129], v[128:129], v[144:145]
    v_pk_add_f32 v[130:131], v[130:131], v[146:147]
    v_pk_fma_f32 v[128:129], v[128:129], v[32:33], v[212:213]
    v_pk_fma_f32 v[130:131], v[130:131], v[34:35], v[214:215]
    buffer_store_dword v128, v208, s[68:71], s15 offen offset:0 sc1
    buffer_store_dword v129, v208, s[68:71], s15 offen offset:2048 sc1
    s_add_u32 s15, s15, 4096
    buffer_store_dword v130, v208, s[68:71], s15 offen offset:0 sc1
    buffer_store_dword v131, v208, s[68:71], s15 offen offset:2048 sc1
    v_dot2_f32_bf16 v36, v2, v245, v36
    v_dot2_f32_bf16 v37, v2, v246, v37
    v_dot2_f32_bf16 v38, v3, v245, v38
    v_dot2_f32_bf16 v39, v3, v246, v39
    v_exp_f32 v52, -v36
    v_exp_f32 v53, -v37
    v_exp_f32 v54, -v38
    v_exp_f32 v55, -v39
    v_pk_add_f32 v[52:53], v[52:53], 1.0 op_sel_hi:[1,0]
    v_pk_add_f32 v[54:55], v[54:55], 1.0 op_sel_hi:[1,0]
    v_rcp_f32 v52, v52
    v_rcp_f32 v53, v53
    v_rcp_f32 v54, v54
    v_rcp_f32 v55, v55
    v_pk_add_f32 v[132:133], v[132:133], v[164:165]
    v_pk_add_f32 v[134:135], v[134:135], v[166:167]
    v_pk_mul_f32 v[36:37], v[36:37], v[52:53]
    v_pk_mul_f32 v[38:39], v[38:39], v[54:55]
    s_waitcnt lgkmcnt(2)
    s_nop 0
    v_pk_add_f32 v[132:133], v[132:133], v[148:149]
    v_pk_add_f32 v[134:135], v[134:135], v[150:151]
    v_pk_fma_f32 v[132:133], v[132:133], v[36:37], v[216:217]
    v_pk_fma_f32 v[134:135], v[134:135], v[38:39], v[218:219]
    s_add_u32 s15, s15, 4096
    buffer_store_dword v132, v208, s[68:71], s15 offen offset:0 sc1
    buffer_store_dword v133, v208, s[68:71], s15 offen offset:2048 sc1
    s_add_u32 s15, s15, 4096
    buffer_store_dword v134, v208, s[68:71], s15 offen offset:0 sc1
    buffer_store_dword v135, v208, s[68:71], s15 offen offset:2048 sc1
    s_waitcnt vmcnt(8)
    s_nop 0
    v_dot2_f32_bf16 v40, v4, v245, v40
    v_dot2_f32_bf16 v41, v4, v246, v41
    v_dot2_f32_bf16 v42, v5, v245, v42
    v_dot2_f32_bf16 v43, v5, v246, v43
    v_exp_f32 v56, -v40
    v_exp_f32 v57, -v41
    v_exp_f32 v58, -v42
    v_exp_f32 v59, -v43
    v_pk_add_f32 v[56:57], v[56:57], 1.0 op_sel_hi:[1,0]
    v_pk_add_f32 v[58:59], v[58:59], 1.0 op_sel_hi:[1,0]
    v_rcp_f32 v56, v56
    v_rcp_f32 v57, v57
    v_rcp_f32 v58, v58
    v_rcp_f32 v59, v59
    v_pk_add_f32 v[136:137], v[136:137], v[168:169]
    v_pk_add_f32 v[138:139], v[138:139], v[170:171]
    v_pk_mul_f32 v[40:41], v[40:41], v[56:57]
    v_pk_mul_f32 v[42:43], v[42:43], v[58:59]
    s_waitcnt lgkmcnt(1)
    s_nop 0
    v_pk_add_f32 v[136:137], v[136:137], v[152:153]
    v_pk_add_f32 v[138:139], v[138:139], v[154:155]
    v_pk_fma_f32 v[136:137], v[136:137], v[40:41], v[220:221]
    v_pk_fma_f32 v[138:139], v[138:139], v[42:43], v[222:223]
    s_add_u32 s15, s15, 4096
    buffer_store_dword v136, v208, s[68:71], s15 offen offset:0 sc1
    buffer_store_dword v137, v208, s[68:71], s15 offen offset:2048 sc1
    s_add_u32 s15, s15, 4096
    buffer_store_dword v138, v208, s[68:71], s15 offen offset:0 sc1
    buffer_store_dword v139, v208, s[68:71], s15 offen offset:2048 sc1
    v_dot2_f32_bf16 v44, v6, v245, v44
    v_dot2_f32_bf16 v45, v6, v246, v45
    v_dot2_f32_bf16 v46, v7, v245, v46
    v_dot2_f32_bf16 v47, v7, v246, v47
    v_exp_f32 v60, -v44
    v_exp_f32 v61, -v45
    v_exp_f32 v62, -v46
    v_exp_f32 v63, -v47
    v_pk_add_f32 v[60:61], v[60:61], 1.0 op_sel_hi:[1,0]
    v_pk_add_f32 v[62:63], v[62:63], 1.0 op_sel_hi:[1,0]
    v_rcp_f32 v60, v60
    v_rcp_f32 v61, v61
    v_rcp_f32 v62, v62
    v_rcp_f32 v63, v63
    v_pk_add_f32 v[140:141], v[140:141], v[172:173]
    v_pk_add_f32 v[142:143], v[142:143], v[174:175]
    v_pk_mul_f32 v[44:45], v[44:45], v[60:61]
    v_pk_mul_f32 v[46:47], v[46:47], v[62:63]
    s_waitcnt lgkmcnt(0)
    s_nop 0
    v_pk_add_f32 v[140:141], v[140:141], v[156:157]
    v_pk_add_f32 v[142:143], v[142:143], v[158:159]
    v_pk_fma_f32 v[140:141], v[140:141], v[44:45], v[224:225]
    v_pk_fma_f32 v[142:143], v[142:143], v[46:47], v[226:227]
    s_add_u32 s15, s15, 4096
    buffer_store_dword v140, v208, s[68:71], s15 offen offset:0 sc1
    buffer_store_dword v141, v208, s[68:71], s15 offen offset:2048 sc1
    s_add_u32 s15, s15, 4096
    buffer_store_dword v142, v208, s[68:71], s15 offen offset:0 sc1
    buffer_store_dword v143, v208, s[68:71], s15 offen offset:2048 sc1
    s_cmp_lg_u32 s17, 60
    s_cbranch_scc1 L_noep
    s_mov_b64 exec, 1
    global_store_dword v211, v252, s[64:65] offset:-128 sc1
L_noep:
    s_mov_b64 exec, 1
L_end:
    s_endpgm
L_sp0:
    s_mov_b32 s101, 0
L_spl0:
    buffer_load_dword v255, v253, s[60:63], s77 offen offset:0 sc1
    s_add_u32 s101, s101, 1
    s_waitcnt vmcnt(0)
    v_cmp_ne_u32 vcc, s74, v255
    s_cmp_gt_u32 s101, 0x40000
    s_cbranch_scc1 L_pr0
    s_cbranch_vccnz L_spl0
    s_branch L_pr0
L_sp1:
    s_mov_b32 s101, 0
L_spl1:
    buffer_load_dword v255, v253, s[60:63], s77 offen offset:1024 sc1
    s_add_u32 s101, s101, 1
    s_waitcnt vmcnt(0)
    v_cmp_ne_u32 vcc, s74, v255
    s_cmp_gt_u32 s101, 0x40000
    s_cbranch_scc1 L_pr1
    s_cbranch_vccnz L_spl1
    s_branch L_pr1
L_sp2:
    s_mov_b32 s101, 0
L_spl2:
    buffer_load_dword v255, v253, s[60:63], s77 offen offset:2048 sc1
    s_add_u32 s101, s101, 1
    s_waitcnt vmcnt(0)
    v_cmp_ne_u32 vcc, s74, v255
    s_cmp_gt_u32 s101, 0x40000
    s_cbranch_scc1 L_pr2
    s_cbranch_vccnz L_spl2
    s_branch L_pr2
L_slb:
    s_mov_b32 s101, 0
L_slbl:
    buffer_load_dwordx4 v[176:179], v246, s[64:67], s21 offen offset:0 sc1
    buffer_load_dwordx4 v[180:183], v246, s[64:67], s21 offen offset:512 sc1
    s_add_u32 s101, s101, 1
    s_waitcnt vmcnt(0)
    v_add_u32 v244, v177, v179
    v_add3_u32 v244, v181, v183, v244
    v_cmp_ne_u32 vcc, v244, v245
    s_cmp_gt_u32 s101, 0x40000
    s_cbranch_scc1 L_rlb
    s_cbranch_vccnz L_slbl
    s_branch L_rlb
L_sp3:
    s_mov_b32 s101, 0
L_spl3:
    buffer_load_dword v255, v253, s[60:63], s18 offen offset:0 sc1
    s_add_u32 s101, s101, 1
    s_waitcnt vmcnt(0)
    v_cmp_ne_u32 vcc, s74, v255
    s_cmp_gt_u32 s101, 0x40000
    s_cbranch_scc1 L_pr3
    s_cbranch_vccnz L_spl3
    s_branch L_pr3
L_sp4:
    s_mov_b32 s101, 0
L_spl4:
    buffer_load_dword v255, off, s[60:63], s19 offset:0 sc1
    s_add_u32 s101, s101, 1
    s_waitcnt vmcnt(0)
    v_cmp_ne_u32 vcc, s74, v255
    s_cmp_gt_u32 s101, 0x40000
    s_cbranch_scc1 L_pr4
    s_cbranch_vccnz L_spl4
    s_branch L_pr4
    s_endpgm
.fill 9472-((.-recurrent_scan__ssm_conv_s5__dense_activation_mish__prompt_kernel)/4), 4, 0xbf810000

.section .rodata,"a"
.p2align 6
.amdhsa_kernel recurrent_scan__ssm_conv_s5__dense_activation_mish__prompt_kernel
  .amdhsa_next_free_vgpr 512
  .amdhsa_next_free_sgpr 102
  .amdhsa_accum_offset 256
  .amdhsa_ieee_mode 0
  .amdhsa_group_segment_fixed_size 0
  .amdhsa_kernarg_size 128
  .amdhsa_user_sgpr_count 2
  .amdhsa_user_sgpr_kernarg_segment_ptr 1
  .amdhsa_system_sgpr_workgroup_id_x 1
.end_amdhsa_kernel
```
